```python
import torch

def _softmax(x, axis=-1):
    return torch.softmax(x, dim=axis)
def _gelu(x):
    return torch.nn.functional.gelu(x, approximate="tanh")
def _silu(x):
    return torch.nn.functional.silu(x)
def _sigmoid(x):
    return torch.sigmoid(x)
def _layernorm(x, axis=-1, eps=1e-5):
    m = x.mean(dim=axis, keepdim=True)
    v = x.var(dim=axis, keepdim=True, unbiased=False)
    return (x - m) / torch.sqrt(v + eps)
def _scatter_add(tgt, idx, src, axis=0):
    return tgt.clone().index_add_(axis, idx, src)
def _segment_sum(src, seg, n):
    out = torch.zeros((n,) + src.shape[1:], dtype=src.dtype)
    return out.index_add_(0, seg, src)
def _pad(x, pw):
    flat = tuple(v for pair in reversed(pw) for v in pair)
    return torch.nn.functional.pad(x, flat)

kernel_name = 'parallel_sum__softmax_full_mha__moe_arch_mod__prompt'

def setup_inputs():

    _w = (lambda a: (lambda t: t.to(torch.bfloat16) if t.is_floating_point() else t)(torch.as_tensor(a)))
    def _A_setup():
        B, S, D = 1, 2048, 640
        return {
            "x": _w((lambda *s: torch.randn(*s, dtype=torch.bfloat16) * 0.05)(B, S, D)),
            "wqkv": _w((lambda *s: torch.randn(*s, dtype=torch.bfloat16) * 0.2)(D, 3 * D)),
            "wo": _w((lambda *s: torch.randn(*s, dtype=torch.bfloat16) * 0.2)(D, D)),
        }
    _A_in = _A_setup()

    def _B_setup():
        B, S, D, F, C = 1, 2048, 640, 1728, 2
        return {
            "x": _w((lambda *s: torch.randn(*s, dtype=torch.bfloat16) * 0.05)(B, S, D)),
            "w_r": _w((lambda *s: torch.randn(*s, dtype=torch.bfloat16) * 0.8)(D)),
            "w_gate": _w((lambda *s: torch.randn(*s, dtype=torch.bfloat16) * 0.2)(D, F)),
            "w_up": _w((lambda *s: torch.randn(*s, dtype=torch.bfloat16) * 0.2)(D, F)),
            "w_down": _w((lambda *s: torch.randn(*s, dtype=torch.bfloat16) * 0.2)(F, D)),
        }
    _B_in = _B_setup()

    return {
        "A_x": _A_in["x"],
        "A_wqkv": _A_in["wqkv"],
        "A_wo": _A_in["wo"],
        "B_x": _B_in["x"],
        "B_w_r": _B_in["w_r"],
        "B_w_gate": _B_in["w_gate"],
        "B_w_up": _B_in["w_up"],
        "B_w_down": _B_in["w_down"],
    }

def reference(A_x, A_wqkv, A_wo, B_x, B_w_r, B_w_gate, B_w_up, B_w_down):
    def _A_ref(x, wqkv, wo):
        B, S, D = x.shape
        H = 32; Dh = D // H
        qkv = (lambda x, *d: x.permute(*d))((x @ wqkv).reshape(B, S, 3, H, Dh), 2, 0, 3, 1, 4)
        q, k, v = qkv[0], qkv[1], qkv[2]
        scale = Dh ** -0.5
        scores = torch.einsum("bhqd,bhkd->bhqk", q, k) * scale
        p = _softmax(scores, axis=-1)
        o = torch.einsum("bhqk,bhkd->bhqd", p, v)
        return (lambda x, *d: x.permute(*d))(o, 0, 2, 1, 3).reshape(B, S, D) @ wo

    def _B_ref(x, w_r, w_gate, w_up, w_down):
        B, S, D = x.shape
        C = 2
        r = x @ w_r
        idx = torch.argsort(-r, axis=-1)[:, :C]
        idx_e = (lambda x, n, axis: torch.repeat_interleave(x, n, dim=axis))(idx.reshape(B, C, 1), D, axis=2)
        x_sel = (lambda x, i, axis: torch.take_along_dim(x, i, dim=axis))(x, idx_e, axis=1)
        g = _silu(x_sel @ w_gate)
        u = x_sel @ w_up
        y = (g * u) @ w_down
        r_sel = _sigmoid((lambda x, i, axis: torch.take_along_dim(x, i, dim=axis))(r, idx, axis=1))
        y = y * r_sel.reshape(B, C, 1)
        b_off = (torch.arange(B) * S).reshape(B, 1)
        flat_idx = (idx + b_off).reshape(B * C)
        zero = (x * 0.0).reshape(B * S, D)
        upd = _scatter_add(zero, flat_idx, y.reshape(B * C, D), axis=0)
        return x + upd.reshape(B, S, D)

    x = A_x
    xn = _layernorm(x, axis=-1)
    return x + _A_ref(xn, A_wqkv, A_wo) + _B_ref(xn, B_w_r, B_w_gate, B_w_up, B_w_down)
```

```asm
; @launch kernel=k1_kernel grid=(256,1,1) block=(768,1,1) lds=150528
; @launch kernel=k2_kernel grid=(256,1,1) block=(320,1,1) lds=153856
.amdgcn_target "amdgcn-amd-amdhsa--gfx950"
.text
.globl k1_kernel
.p2align 8
.type k1_kernel,@function
k1_kernel:
    s_cmp_ge_u32 s2, 256
    s_cbranch_scc1 K1_END
    s_getpc_b64 s[46:47]
.Lpc_k1:
    v_lshlrev_b32 v3, 6, v0
    v_min_u32 v3, K2_END - .Lpc_k1, v3
    global_load_dword v167, v3, s[46:47]
    s_load_dwordx4 s[4:7], s[0:1], 0
    s_load_dwordx2 s[8:9], s[0:1], 32
    s_load_dwordx2 s[10:11], s[0:1], 80
    s_and_b32 s40, s2, 7
    s_lshr_b32 s41, s2, 3
    s_and_b32 s28, s40, 1
    s_lshl_b32 s28, s28, 3
    s_and_b32 s42, s41, 7
    s_add_u32 s28, s28, s42
    s_lshr_b32 s29, s40, 1
    s_lshl_b32 s29, s29, 2
    s_lshr_b32 s42, s41, 3
    s_add_u32 s29, s29, s42
    v_lshrrev_b32 v1, 6, v0
    v_and_b32 v2, 63, v0
    v_readfirstlane_b32 s30, v1
    s_mul_i32 s41, s29, 3
    s_mul_i32 s42, s28, 1
    s_add_u32 s41, s41, s42
    s_mul_i32 s42, s41, 52429
    s_lshr_b32 s42, s42, 19
    s_mul_i32 s42, s42, 10
    s_sub_u32 s43, s41, s42
    s_cmp_lt_u32 s30, 4
    s_cbranch_scc1 K1_COMP
    s_setprio 3
    s_cmp_ge_u32 s30, 8
    s_cbranch_scc1 K1_SW
    s_sub_u32 s31, s30, 4
    s_and_b32 s32, s31, 1
    s_mov_b32 s47, s43
    v_lshrrev_b32 v11, 4, v2
    v_lshlrev_b32 v12, 2, v11
    v_and_b32 v13, 15, v2
    v_sub_u32 v13, v13, v12
    v_and_b32 v13, 15, v13
    s_lshl_b32 s34, s31, 2
    v_add_u32 v11, s34, v11
    v_mul_u32_u24 v5, 3840, v11
    v_lshl_add_u32 v5, v13, 4, v5
    s_mul_i32 s34, s28, 240
    v_add_u32 v5, s34, v5
    s_lshl_b32 s48, s31, 10
    s_add_u32 s48, s48, 65536
    s_lshl_b32 s34, s31, 3
    v_lshrrev_b32 v11, 3, v2
    v_add_u32 v11, s34, v11
    v_mul_u32_u24 v4, 1280, v11
    s_lshl_b32 s34, s32, 2
    v_lshrrev_b32 v13, 4, v2
    v_add_u32 v13, s34, v13
    v_and_b32 v12, 7, v2
    v_xor_b32 v12, v12, v13
    v_lshl_add_u32 v4, v12, 4, v4
    s_lshl_b32 s34, s31, 10
    s_mul_i32 s33, s29, 163840
    s_waitcnt lgkmcnt(0)
    s_mov_b32 s16, s6
    s_and_b32 s17, s7, 0xffff
    s_mov_b32 s18, 2457600
    s_mov_b32 s19, 0x00020000
    s_mov_b32 s12, s4
    s_and_b32 s13, s5, 0xffff
    s_mov_b32 s14, 2621440
    s_mov_b32 s15, 0x00020000
    s_call_b64 s[60:61], K1_XS
    s_call_b64 s[60:61], K1_WS
    s_barrier
    s_call_b64 s[60:61], K1_XS
    s_call_b64 s[60:61], K1_WS
    s_mov_b32 s24, s10
    s_and_b32 s25, s11, 0xffff
    s_mov_b32 s26, 16777216
    s_mov_b32 s27, 0x00020000
    v_mov_b32 v8, 0xffff0000
    s_mov_b32 s20, s8
    s_and_b32 s21, s9, 0xffff
    s_mov_b32 s22, 1280
    s_mov_b32 s23, 0x00020000
    v_and_b32 v3, 15, v2
    v_lshrrev_b32 v9, 4, v2
    v_lshlrev_b32 v10, 4, v3
    s_lshl_b32 s35, s28, 3
    s_lshl_b32 s36, s32, 2
    s_add_u32 s35, s35, s36
    v_add_u32 v11, s35, v9
    v_mul_u32_u24 v6, 1280, v11
    v_add_u32 v6, v6, v10
    s_cmp_ge_u32 s31, 2
    s_cbranch_scc1 K1_PLN
    s_waitcnt vmcnt(8)
    s_barrier
    s_call_b64 s[60:61], K1_XS
    s_call_b64 s[60:61], K1_XS
    s_call_b64 s[60:61], K1_WS
    s_call_b64 s[60:61], K1_WS
    s_call_b64 s[60:61], K1_WS
    s_waitcnt vmcnt(20)
    s_barrier
    s_call_b64 s[60:61], K1_XS
    s_call_b64 s[60:61], K1_WS
    s_waitcnt vmcnt(16)
    s_barrier
    s_call_b64 s[60:61], K1_XS
    s_call_b64 s[60:61], K1_WS
    s_waitcnt vmcnt(20)
    s_barrier
    s_call_b64 s[60:61], K1_XS
    s_call_b64 s[60:61], K1_WS
    s_waitcnt vmcnt(20)
    s_barrier
    s_call_b64 s[60:61], K1_XS
    s_call_b64 s[60:61], K1_WS
    s_waitcnt vmcnt(20)
    s_barrier
    s_call_b64 s[60:61], K1_XS
    s_call_b64 s[60:61], K1_WS
    s_waitcnt vmcnt(20)
    s_barrier
    s_call_b64 s[60:61], K1_XS
    s_waitcnt vmcnt(16)
    s_barrier
    s_waitcnt vmcnt(8)
    s_barrier
    s_waitcnt vmcnt(0)
    s_barrier
    s_branch K1_PEND
K1_PLN:
    s_nop 1
    s_waitcnt vmcnt(8)
    s_barrier
    s_call_b64 s[60:61], K1_XS
    s_call_b64 s[60:61], K1_XS
    s_call_b64 s[60:61], K1_WS
    s_call_b64 s[60:61], K1_WS
    s_call_b64 s[60:61], K1_WS
    s_waitcnt vmcnt(20)
    s_barrier
    s_call_b64 s[60:61], K1_XS
    s_call_b64 s[60:61], K1_WS
    buffer_load_dwordx4 v[40:43], v6, s[12:15], s33 offen offset:0
    buffer_load_dwordx4 v[60:63], v10, s[20:23], 0 offen offset:0
    buffer_load_dwordx4 v[44:47], v6, s[12:15], s33 offen offset:256
    buffer_load_dwordx4 v[64:67], v10, s[20:23], 0 offen offset:256
    buffer_load_dwordx4 v[48:51], v6, s[12:15], s33 offen offset:512
    buffer_load_dwordx4 v[68:71], v10, s[20:23], 0 offen offset:512
    buffer_load_dwordx4 v[52:55], v6, s[12:15], s33 offen offset:768
    buffer_load_dwordx4 v[72:75], v10, s[20:23], 0 offen offset:768
    buffer_load_dwordx4 v[56:59], v6, s[12:15], s33 offen offset:1024
    buffer_load_dwordx4 v[76:79], v10, s[20:23], 0 offen offset:1024
    s_waitcnt vmcnt(26)
    s_barrier
    s_call_b64 s[60:61], K1_XS
    s_call_b64 s[60:61], K1_WS
    s_waitcnt vmcnt(30)
    s_barrier
    s_call_b64 s[60:61], K1_XS
    s_call_b64 s[60:61], K1_WS
    s_waitcnt vmcnt(30)
    s_barrier
    s_call_b64 s[60:61], K1_XS
    s_call_b64 s[60:61], K1_WS
    s_waitcnt vmcnt(24)
    v_mov_b32 v10, 0
    v_mov_b32 v11, 0
    v_mov_b32 v12, 0
    v_mov_b32 v13, 0
    v_lshlrev_b32 v21, 16, v40
    v_and_b32 v22, v8, v40
    v_add_f32 v10, v10, v21
    v_add_f32 v11, v11, v22
    v_fmac_f32 v12, v21, v21
    v_fmac_f32 v13, v22, v22
    v_lshlrev_b32 v21, 16, v41
    v_and_b32 v22, v8, v41
    v_add_f32 v10, v10, v21
    v_add_f32 v11, v11, v22
    v_fmac_f32 v12, v21, v21
    v_fmac_f32 v13, v22, v22
    v_lshlrev_b32 v21, 16, v42
    v_and_b32 v22, v8, v42
    v_add_f32 v10, v10, v21
    v_add_f32 v11, v11, v22
    v_fmac_f32 v12, v21, v21
    v_fmac_f32 v13, v22, v22
    v_lshlrev_b32 v21, 16, v43
    v_and_b32 v22, v8, v43
    v_add_f32 v10, v10, v21
    v_add_f32 v11, v11, v22
    v_fmac_f32 v12, v21, v21
    v_fmac_f32 v13, v22, v22
    v_lshlrev_b32 v21, 16, v44
    v_and_b32 v22, v8, v44
    v_add_f32 v10, v10, v21
    v_add_f32 v11, v11, v22
    v_fmac_f32 v12, v21, v21
    v_fmac_f32 v13, v22, v22
    v_lshlrev_b32 v21, 16, v45
    v_and_b32 v22, v8, v45
    v_add_f32 v10, v10, v21
    v_add_f32 v11, v11, v22
    v_fmac_f32 v12, v21, v21
    v_fmac_f32 v13, v22, v22
    v_lshlrev_b32 v21, 16, v46
    v_and_b32 v22, v8, v46
    v_add_f32 v10, v10, v21
    v_add_f32 v11, v11, v22
    v_fmac_f32 v12, v21, v21
    v_fmac_f32 v13, v22, v22
    v_lshlrev_b32 v21, 16, v47
    v_and_b32 v22, v8, v47
    v_add_f32 v10, v10, v21
    v_add_f32 v11, v11, v22
    v_fmac_f32 v12, v21, v21
    v_fmac_f32 v13, v22, v22
    v_lshlrev_b32 v21, 16, v48
    v_and_b32 v22, v8, v48
    v_add_f32 v10, v10, v21
    v_add_f32 v11, v11, v22
    v_fmac_f32 v12, v21, v21
    v_fmac_f32 v13, v22, v22
    v_lshlrev_b32 v21, 16, v49
    v_and_b32 v22, v8, v49
    v_add_f32 v10, v10, v21
    v_add_f32 v11, v11, v22
    v_fmac_f32 v12, v21, v21
    v_fmac_f32 v13, v22, v22
    s_waitcnt vmcnt(20)
    s_barrier
    s_call_b64 s[60:61], K1_XS
    s_call_b64 s[60:61], K1_WS
    v_lshlrev_b32 v21, 16, v50
    v_and_b32 v22, v8, v50
    v_add_f32 v10, v10, v21
    v_add_f32 v11, v11, v22
    v_fmac_f32 v12, v21, v21
    v_fmac_f32 v13, v22, v22
    v_lshlrev_b32 v21, 16, v51
    v_and_b32 v22, v8, v51
    v_add_f32 v10, v10, v21
    v_add_f32 v11, v11, v22
    v_fmac_f32 v12, v21, v21
    v_fmac_f32 v13, v22, v22
    v_lshlrev_b32 v21, 16, v52
    v_and_b32 v22, v8, v52
    v_add_f32 v10, v10, v21
    v_add_f32 v11, v11, v22
    v_fmac_f32 v12, v21, v21
    v_fmac_f32 v13, v22, v22
    v_lshlrev_b32 v21, 16, v53
    v_and_b32 v22, v8, v53
    v_add_f32 v10, v10, v21
    v_add_f32 v11, v11, v22
    v_fmac_f32 v12, v21, v21
    v_fmac_f32 v13, v22, v22
    v_lshlrev_b32 v21, 16, v54
    v_and_b32 v22, v8, v54
    v_add_f32 v10, v10, v21
    v_add_f32 v11, v11, v22
    v_fmac_f32 v12, v21, v21
    v_fmac_f32 v13, v22, v22
    v_lshlrev_b32 v21, 16, v55
    v_and_b32 v22, v8, v55
    v_add_f32 v10, v10, v21
    v_add_f32 v11, v11, v22
    v_fmac_f32 v12, v21, v21
    v_fmac_f32 v13, v22, v22
    v_lshlrev_b32 v21, 16, v56
    v_and_b32 v22, v8, v56
    v_add_f32 v10, v10, v21
    v_add_f32 v11, v11, v22
    v_fmac_f32 v12, v21, v21
    v_fmac_f32 v13, v22, v22
    v_lshlrev_b32 v21, 16, v57
    v_and_b32 v22, v8, v57
    v_add_f32 v10, v10, v21
    v_add_f32 v11, v11, v22
    v_fmac_f32 v12, v21, v21
    v_fmac_f32 v13, v22, v22
    v_lshlrev_b32 v21, 16, v58
    v_and_b32 v22, v8, v58
    v_add_f32 v10, v10, v21
    v_add_f32 v11, v11, v22
    v_fmac_f32 v12, v21, v21
    v_fmac_f32 v13, v22, v22
    v_lshlrev_b32 v21, 16, v59
    v_and_b32 v22, v8, v59
    v_add_f32 v10, v10, v21
    v_add_f32 v11, v11, v22
    v_fmac_f32 v12, v21, v21
    v_fmac_f32 v13, v22, v22
    v_add_f32 v10, v10, v11
    v_add_f32 v12, v12, v13
    s_nop 0
    v_add_f32_dpp v10, v10, v10 row_ror:8 row_mask:0xf bank_mask:0xf
    v_add_f32_dpp v12, v12, v12 row_ror:8 row_mask:0xf bank_mask:0xf
    s_nop 0
    v_add_f32_dpp v10, v10, v10 row_ror:4 row_mask:0xf bank_mask:0xf
    v_add_f32_dpp v12, v12, v12 row_ror:4 row_mask:0xf bank_mask:0xf
    s_nop 0
    v_add_f32_dpp v10, v10, v10 row_ror:2 row_mask:0xf bank_mask:0xf
    v_add_f32_dpp v12, v12, v12 row_ror:2 row_mask:0xf bank_mask:0xf
    s_nop 0
    v_add_f32_dpp v10, v10, v10 row_ror:1 row_mask:0xf bank_mask:0xf
    v_add_f32_dpp v12, v12, v12 row_ror:1 row_mask:0xf bank_mask:0xf
    v_mul_f32 v10, 0x3acccccd, v10
    v_mul_f32 v12, 0x3acccccd, v12
    v_fma_f32 v12, -v10, v10, v12
    v_max_f32 v12, 0, v12
    v_cvt_pk_bf16_f32 v18, 0, v10
    v_cvt_pk_bf16_f32 v12, 0, v12
    v_add_f32 v12, 0x3727c5ac, v12
    v_cvt_pk_bf16_f32 v12, 0, v12
    v_sqrt_f32 v12, v12
    s_nop 0
    v_cvt_pk_bf16_f32 v12, 0, v12
    v_rcp_f32 v19, v12
    v_mov_b32 v10, 0
    v_mov_b32 v11, 0
    s_waitcnt vmcnt(20)
    s_barrier
    s_call_b64 s[60:61], K1_XS
    v_lshlrev_b32 v21, 16, v40
    v_and_b32 v22, v8, v40
    v_sub_f32 v21, v21, v18
    v_sub_f32 v22, v22, v18
    v_cvt_pk_bf16_f32 v21, 0, v21
    v_cvt_pk_bf16_f32 v22, 0, v22
    v_mul_f32 v21, v21, v19
    v_mul_f32 v22, v22, v19
    v_cvt_pk_bf16_f32 v21, 0, v21
    v_cvt_pk_bf16_f32 v22, 0, v22
    v_lshlrev_b32 v23, 16, v60
    v_and_b32 v24, v8, v60
    v_fmac_f32 v10, v21, v23
    v_fmac_f32 v11, v22, v24
    v_lshlrev_b32 v21, 16, v41
    v_and_b32 v22, v8, v41
    v_sub_f32 v21, v21, v18
    v_sub_f32 v22, v22, v18
    v_cvt_pk_bf16_f32 v21, 0, v21
    v_cvt_pk_bf16_f32 v22, 0, v22
    v_mul_f32 v21, v21, v19
    v_mul_f32 v22, v22, v19
    v_cvt_pk_bf16_f32 v21, 0, v21
    v_cvt_pk_bf16_f32 v22, 0, v22
    v_lshlrev_b32 v23, 16, v61
    v_and_b32 v24, v8, v61
    v_fmac_f32 v10, v21, v23
    v_fmac_f32 v11, v22, v24
    v_lshlrev_b32 v21, 16, v42
    v_and_b32 v22, v8, v42
    v_sub_f32 v21, v21, v18
    v_sub_f32 v22, v22, v18
    v_cvt_pk_bf16_f32 v21, 0, v21
    v_cvt_pk_bf16_f32 v22, 0, v22
    v_mul_f32 v21, v21, v19
    v_mul_f32 v22, v22, v19
    v_cvt_pk_bf16_f32 v21, 0, v21
    v_cvt_pk_bf16_f32 v22, 0, v22
    v_lshlrev_b32 v23, 16, v62
    v_and_b32 v24, v8, v62
    v_fmac_f32 v10, v21, v23
    v_fmac_f32 v11, v22, v24
    v_lshlrev_b32 v21, 16, v43
    v_and_b32 v22, v8, v43
    v_sub_f32 v21, v21, v18
    v_sub_f32 v22, v22, v18
    v_cvt_pk_bf16_f32 v21, 0, v21
    v_cvt_pk_bf16_f32 v22, 0, v22
    v_mul_f32 v21, v21, v19
    v_mul_f32 v22, v22, v19
    v_cvt_pk_bf16_f32 v21, 0, v21
    v_cvt_pk_bf16_f32 v22, 0, v22
    v_lshlrev_b32 v23, 16, v63
    v_and_b32 v24, v8, v63
    v_fmac_f32 v10, v21, v23
    v_fmac_f32 v11, v22, v24
    v_lshlrev_b32 v21, 16, v44
    v_and_b32 v22, v8, v44
    v_sub_f32 v21, v21, v18
    v_sub_f32 v22, v22, v18
    v_cvt_pk_bf16_f32 v21, 0, v21
    v_cvt_pk_bf16_f32 v22, 0, v22
    v_mul_f32 v21, v21, v19
    v_mul_f32 v22, v22, v19
    v_cvt_pk_bf16_f32 v21, 0, v21
    v_cvt_pk_bf16_f32 v22, 0, v22
    v_lshlrev_b32 v23, 16, v64
    v_and_b32 v24, v8, v64
    v_fmac_f32 v10, v21, v23
    v_fmac_f32 v11, v22, v24
    s_waitcnt vmcnt(16)
    s_barrier
    v_lshlrev_b32 v21, 16, v45
    v_and_b32 v22, v8, v45
    v_sub_f32 v21, v21, v18
    v_sub_f32 v22, v22, v18
    v_cvt_pk_bf16_f32 v21, 0, v21
    v_cvt_pk_bf16_f32 v22, 0, v22
    v_mul_f32 v21, v21, v19
    v_mul_f32 v22, v22, v19
    v_cvt_pk_bf16_f32 v21, 0, v21
    v_cvt_pk_bf16_f32 v22, 0, v22
    v_lshlrev_b32 v23, 16, v65
    v_and_b32 v24, v8, v65
    v_fmac_f32 v10, v21, v23
    v_fmac_f32 v11, v22, v24
    v_lshlrev_b32 v21, 16, v46
    v_and_b32 v22, v8, v46
    v_sub_f32 v21, v21, v18
    v_sub_f32 v22, v22, v18
    v_cvt_pk_bf16_f32 v21, 0, v21
    v_cvt_pk_bf16_f32 v22, 0, v22
    v_mul_f32 v21, v21, v19
    v_mul_f32 v22, v22, v19
    v_cvt_pk_bf16_f32 v21, 0, v21
    v_cvt_pk_bf16_f32 v22, 0, v22
    v_lshlrev_b32 v23, 16, v66
    v_and_b32 v24, v8, v66
    v_fmac_f32 v10, v21, v23
    v_fmac_f32 v11, v22, v24
    v_lshlrev_b32 v21, 16, v47
    v_and_b32 v22, v8, v47
    v_sub_f32 v21, v21, v18
    v_sub_f32 v22, v22, v18
    v_cvt_pk_bf16_f32 v21, 0, v21
    v_cvt_pk_bf16_f32 v22, 0, v22
    v_mul_f32 v21, v21, v19
    v_mul_f32 v22, v22, v19
    v_cvt_pk_bf16_f32 v21, 0, v21
    v_cvt_pk_bf16_f32 v22, 0, v22
    v_lshlrev_b32 v23, 16, v67
    v_and_b32 v24, v8, v67
    v_fmac_f32 v10, v21, v23
    v_fmac_f32 v11, v22, v24
    v_lshlrev_b32 v21, 16, v48
    v_and_b32 v22, v8, v48
    v_sub_f32 v21, v21, v18
    v_sub_f32 v22, v22, v18
    v_cvt_pk_bf16_f32 v21, 0, v21
    v_cvt_pk_bf16_f32 v22, 0, v22
    v_mul_f32 v21, v21, v19
    v_mul_f32 v22, v22, v19
    v_cvt_pk_bf16_f32 v21, 0, v21
    v_cvt_pk_bf16_f32 v22, 0, v22
    v_lshlrev_b32 v23, 16, v68
    v_and_b32 v24, v8, v68
    v_fmac_f32 v10, v21, v23
    v_fmac_f32 v11, v22, v24
    v_lshlrev_b32 v21, 16, v49
    v_and_b32 v22, v8, v49
    v_sub_f32 v21, v21, v18
    v_sub_f32 v22, v22, v18
    v_cvt_pk_bf16_f32 v21, 0, v21
    v_cvt_pk_bf16_f32 v22, 0, v22
    v_mul_f32 v21, v21, v19
    v_mul_f32 v22, v22, v19
    v_cvt_pk_bf16_f32 v21, 0, v21
    v_cvt_pk_bf16_f32 v22, 0, v22
    v_lshlrev_b32 v23, 16, v69
    v_and_b32 v24, v8, v69
    v_fmac_f32 v10, v21, v23
    v_fmac_f32 v11, v22, v24
    s_waitcnt vmcnt(8)
    s_barrier
    v_lshlrev_b32 v21, 16, v50
    v_and_b32 v22, v8, v50
    v_sub_f32 v21, v21, v18
    v_sub_f32 v22, v22, v18
    v_cvt_pk_bf16_f32 v21, 0, v21
    v_cvt_pk_bf16_f32 v22, 0, v22
    v_mul_f32 v21, v21, v19
    v_mul_f32 v22, v22, v19
    v_cvt_pk_bf16_f32 v21, 0, v21
    v_cvt_pk_bf16_f32 v22, 0, v22
    v_lshlrev_b32 v23, 16, v70
    v_and_b32 v24, v8, v70
    v_fmac_f32 v10, v21, v23
    v_fmac_f32 v11, v22, v24
    v_lshlrev_b32 v21, 16, v51
    v_and_b32 v22, v8, v51
    v_sub_f32 v21, v21, v18
    v_sub_f32 v22, v22, v18
    v_cvt_pk_bf16_f32 v21, 0, v21
    v_cvt_pk_bf16_f32 v22, 0, v22
    v_mul_f32 v21, v21, v19
    v_mul_f32 v22, v22, v19
    v_cvt_pk_bf16_f32 v21, 0, v21
    v_cvt_pk_bf16_f32 v22, 0, v22
    v_lshlrev_b32 v23, 16, v71
    v_and_b32 v24, v8, v71
    v_fmac_f32 v10, v21, v23
    v_fmac_f32 v11, v22, v24
    v_lshlrev_b32 v21, 16, v52
    v_and_b32 v22, v8, v52
    v_sub_f32 v21, v21, v18
    v_sub_f32 v22, v22, v18
    v_cvt_pk_bf16_f32 v21, 0, v21
    v_cvt_pk_bf16_f32 v22, 0, v22
    v_mul_f32 v21, v21, v19
    v_mul_f32 v22, v22, v19
    v_cvt_pk_bf16_f32 v21, 0, v21
    v_cvt_pk_bf16_f32 v22, 0, v22
    v_lshlrev_b32 v23, 16, v72
    v_and_b32 v24, v8, v72
    v_fmac_f32 v10, v21, v23
    v_fmac_f32 v11, v22, v24
    v_lshlrev_b32 v21, 16, v53
    v_and_b32 v22, v8, v53
    v_sub_f32 v21, v21, v18
    v_sub_f32 v22, v22, v18
    v_cvt_pk_bf16_f32 v21, 0, v21
    v_cvt_pk_bf16_f32 v22, 0, v22
    v_mul_f32 v21, v21, v19
    v_mul_f32 v22, v22, v19
    v_cvt_pk_bf16_f32 v21, 0, v21
    v_cvt_pk_bf16_f32 v22, 0, v22
    v_lshlrev_b32 v23, 16, v73
    v_and_b32 v24, v8, v73
    v_fmac_f32 v10, v21, v23
    v_fmac_f32 v11, v22, v24
    v_lshlrev_b32 v21, 16, v54
    v_and_b32 v22, v8, v54
    v_sub_f32 v21, v21, v18
    v_sub_f32 v22, v22, v18
    v_cvt_pk_bf16_f32 v21, 0, v21
    v_cvt_pk_bf16_f32 v22, 0, v22
    v_mul_f32 v21, v21, v19
    v_mul_f32 v22, v22, v19
    v_cvt_pk_bf16_f32 v21, 0, v21
    v_cvt_pk_bf16_f32 v22, 0, v22
    v_lshlrev_b32 v23, 16, v74
    v_and_b32 v24, v8, v74
    v_fmac_f32 v10, v21, v23
    v_fmac_f32 v11, v22, v24
    s_waitcnt vmcnt(0)
    s_barrier
    v_lshlrev_b32 v21, 16, v55
    v_and_b32 v22, v8, v55
    v_sub_f32 v21, v21, v18
    v_sub_f32 v22, v22, v18
    v_cvt_pk_bf16_f32 v21, 0, v21
    v_cvt_pk_bf16_f32 v22, 0, v22
    v_mul_f32 v21, v21, v19
    v_mul_f32 v22, v22, v19
    v_cvt_pk_bf16_f32 v21, 0, v21
    v_cvt_pk_bf16_f32 v22, 0, v22
    v_lshlrev_b32 v23, 16, v75
    v_and_b32 v24, v8, v75
    v_fmac_f32 v10, v21, v23
    v_fmac_f32 v11, v22, v24
    v_lshlrev_b32 v21, 16, v56
    v_and_b32 v22, v8, v56
    v_sub_f32 v21, v21, v18
    v_sub_f32 v22, v22, v18
    v_cvt_pk_bf16_f32 v21, 0, v21
    v_cvt_pk_bf16_f32 v22, 0, v22
    v_mul_f32 v21, v21, v19
    v_mul_f32 v22, v22, v19
    v_cvt_pk_bf16_f32 v21, 0, v21
    v_cvt_pk_bf16_f32 v22, 0, v22
    v_lshlrev_b32 v23, 16, v76
    v_and_b32 v24, v8, v76
    v_fmac_f32 v10, v21, v23
    v_fmac_f32 v11, v22, v24
    v_lshlrev_b32 v21, 16, v57
    v_and_b32 v22, v8, v57
    v_sub_f32 v21, v21, v18
    v_sub_f32 v22, v22, v18
    v_cvt_pk_bf16_f32 v21, 0, v21
    v_cvt_pk_bf16_f32 v22, 0, v22
    v_mul_f32 v21, v21, v19
    v_mul_f32 v22, v22, v19
    v_cvt_pk_bf16_f32 v21, 0, v21
    v_cvt_pk_bf16_f32 v22, 0, v22
    v_lshlrev_b32 v23, 16, v77
    v_and_b32 v24, v8, v77
    v_fmac_f32 v10, v21, v23
    v_fmac_f32 v11, v22, v24
    v_lshlrev_b32 v21, 16, v58
    v_and_b32 v22, v8, v58
    v_sub_f32 v21, v21, v18
    v_sub_f32 v22, v22, v18
    v_cvt_pk_bf16_f32 v21, 0, v21
    v_cvt_pk_bf16_f32 v22, 0, v22
    v_mul_f32 v21, v21, v19
    v_mul_f32 v22, v22, v19
    v_cvt_pk_bf16_f32 v21, 0, v21
    v_cvt_pk_bf16_f32 v22, 0, v22
    v_lshlrev_b32 v23, 16, v78
    v_and_b32 v24, v8, v78
    v_fmac_f32 v10, v21, v23
    v_fmac_f32 v11, v22, v24
    v_lshlrev_b32 v21, 16, v59
    v_and_b32 v22, v8, v59
    v_sub_f32 v21, v21, v18
    v_sub_f32 v22, v22, v18
    v_cvt_pk_bf16_f32 v21, 0, v21
    v_cvt_pk_bf16_f32 v22, 0, v22
    v_mul_f32 v21, v21, v19
    v_mul_f32 v22, v22, v19
    v_cvt_pk_bf16_f32 v21, 0, v21
    v_cvt_pk_bf16_f32 v22, 0, v22
    v_lshlrev_b32 v23, 16, v79
    v_and_b32 v24, v8, v79
    v_fmac_f32 v10, v21, v23
    v_fmac_f32 v11, v22, v24
    v_add_f32 v10, v10, v11
    s_nop 1
    v_add_f32_dpp v10, v10, v10 row_ror:8 row_mask:0xf bank_mask:0xf
    s_nop 1
    v_add_f32_dpp v10, v10, v10 row_ror:4 row_mask:0xf bank_mask:0xf
    s_nop 1
    v_add_f32_dpp v10, v10, v10 row_ror:2 row_mask:0xf bank_mask:0xf
    s_nop 1
    v_add_f32_dpp v10, v10, v10 row_ror:1 row_mask:0xf bank_mask:0xf
    v_cvt_pk_bf16_f32 v10, 0, v10
    v_add_u32 v11, s35, v9
    v_ashrrev_i32 v12, 31, v10
    v_or_b32 v12, 0x80000000, v12
    v_xor_b32 v10, v10, v12
    v_and_b32 v10, 0xffff0000, v10
    s_lshl_b32 s36, s29, 7
    v_add_u32 v12, s36, v11
    v_sub_u32 v12, 2047, v12
    v_or_b32 v10, v10, v12
    v_lshlrev_b32 v11, 2, v11
    s_lshl_b32 s36, s29, 9
    s_add_u32 s36, s36, 14680064
    v_cmp_eq_u32 vcc, 0, v3
    s_nop 0
    s_and_saveexec_b64 s[38:39], vcc
    buffer_store_dword v10, v11, s[24:27], s36 offen
    v_lshlrev_b32 v11, 1, v11
    s_lshl_b32 s36, s29, 10
    s_add_u32 s36, s36, 9437184
    buffer_store_dwordx2 v[18:19], v11, s[24:27], s36 offen
    s_mov_b64 exec, s[38:39]
K1_PEND:
    s_nop 1
    s_barrier
    s_cmp_lg_u32 s2, 0
    s_cbranch_scc1 K1_COPY
    s_cmp_lg_u32 s31, 0
    s_cbranch_scc1 K1_COPY
    v_mov_b32 v12, 0
    v_mov_b32 v13, 0
    v_mov_b32 v14, 0
    v_mov_b32 v15, 0
    v_lshlrev_b32 v10, 4, v2
    s_mov_b32 s36, 14745600
    buffer_store_dwordx4 v[12:15], v10, s[24:27], s36 offen offset:0
    buffer_store_dwordx4 v[12:15], v10, s[24:27], s36 offen offset:1024
    buffer_store_dwordx4 v[12:15], v10, s[24:27], s36 offen offset:2048
    buffer_store_dwordx4 v[12:15], v10, s[24:27], s36 offen offset:3072
    s_mov_b32 s36, 14749696
    buffer_store_dwordx4 v[12:15], v10, s[24:27], s36 offen offset:0
    buffer_store_dwordx4 v[12:15], v10, s[24:27], s36 offen offset:1024
    buffer_store_dwordx4 v[12:15], v10, s[24:27], s36 offen offset:2048
    buffer_store_dwordx4 v[12:15], v10, s[24:27], s36 offen offset:3072
    s_mov_b32 s36, 14753792
    buffer_store_dwordx4 v[12:15], v10, s[24:27], s36 offen offset:0
    s_branch K1_COPY
K1_WS:
    s_mul_i32 s40, s47, 245760
    s_add_u32 s47, s47, 1
    s_cmp_eq_u32 s47, 10
    s_cselect_b32 s47, 0, s47
    s_add_u32 m0, s48, 0
    s_nop 0
    buffer_load_dwordx4 v5, s[16:19], s40 offen lds
    s_add_u32 m0, s48, 4096
    s_add_u32 s40, s40, 61440
    buffer_load_dwordx4 v5, s[16:19], s40 offen lds
    s_add_u32 m0, s48, 8192
    s_add_u32 s40, s40, 61440
    buffer_load_dwordx4 v5, s[16:19], s40 offen lds
    s_add_u32 m0, s48, 12288
    s_add_u32 s40, s40, 61440
    buffer_load_dwordx4 v5, s[16:19], s40 offen lds
    s_add_u32 s48, s48, 16384
    s_cmp_ge_u32 s48, 147456
    s_cselect_b32 s45, 81920, 0
    s_sub_u32 s48, s48, s45
    s_setpc_b64 s[60:61]
K1_XS:
    s_lshl_b32 s40, s43, 7
    s_add_u32 s40, s40, s33
    s_add_u32 s43, s43, 1
    s_cmp_eq_u32 s43, 10
    s_cselect_b32 s43, 0, s43
    s_add_u32 m0, s34, 0
    s_nop 0
    buffer_load_dwordx4 v4, s[12:15], s40 offen lds
    s_add_u32 m0, s34, 4096
    s_add_u32 s40, s40, 40960
    buffer_load_dwordx4 v4, s[12:15], s40 offen lds
    s_add_u32 m0, s34, 8192
    s_add_u32 s40, s40, 40960
    buffer_load_dwordx4 v4, s[12:15], s40 offen lds
    s_add_u32 m0, s34, 12288
    s_add_u32 s40, s40, 40960
    buffer_load_dwordx4 v4, s[12:15], s40 offen lds
    s_add_u32 s34, s34, 16384
    s_cmp_ge_u32 s34, 65536
    s_cselect_b32 s45, 65536, 0
    s_sub_u32 s34, s34, s45
    s_setpc_b64 s[60:61]
K1_SW:
    s_nop 1
    s_barrier
    s_sub_u32 s31, s30, 8
    v_mov_b32 v7, 0x3f803f80
    v_lshrrev_b32 v20, 5, v2
    v_and_b32 v15, 31, v2
    v_bfe_u32 v16, v2, 1, 3
    v_xor_b32 v16, v16, v20
    v_lshlrev_b32 v17, 7, v15
    s_lshl_b32 s37, s31, 12
    v_add_u32 v17, s37, v17
    v_xor_b32 v34, 0, v16
    v_lshl_add_u32 v26, v34, 4, v17
    v_xor_b32 v34, 2, v16
    v_lshl_add_u32 v27, v34, 4, v17
    v_xor_b32 v34, 4, v16
    v_lshl_add_u32 v28, v34, 4, v17
    v_xor_b32 v34, 6, v16
    v_lshl_add_u32 v29, v34, 4, v17
    v_mov_b32 v96, 0
    v_mov_b32 v97, 0
    v_mov_b32 v98, 0
    v_mov_b32 v99, 0
    s_mov_b32 s44, 0
    s_mov_b32 s46, 0
K1_SL:
    v_add_u32 v30, s46, v26
    v_add_u32 v31, s46, v27
    v_add_u32 v32, s46, v28
    v_add_u32 v33, s46, v29
    s_barrier
    ds_read_b128 v[80:83], v30
    ds_read_b128 v[84:87], v31
    ds_read_b128 v[88:91], v32
    ds_read_b128 v[92:95], v33
    s_waitcnt lgkmcnt(3)
    v_dot2_f32_bf16 v96, v80, v7, v96
    v_dot2_f32_bf16 v98, v80, v80, v98
    v_dot2_f32_bf16 v97, v81, v7, v97
    v_dot2_f32_bf16 v99, v81, v81, v99
    v_dot2_f32_bf16 v96, v82, v7, v96
    v_dot2_f32_bf16 v98, v82, v82, v98
    v_dot2_f32_bf16 v97, v83, v7, v97
    v_dot2_f32_bf16 v99, v83, v83, v99
    s_waitcnt lgkmcnt(2)
    v_dot2_f32_bf16 v96, v84, v7, v96
    v_dot2_f32_bf16 v98, v84, v84, v98
    v_dot2_f32_bf16 v97, v85, v7, v97
    v_dot2_f32_bf16 v99, v85, v85, v99
    v_dot2_f32_bf16 v96, v86, v7, v96
    v_dot2_f32_bf16 v98, v86, v86, v98
    v_dot2_f32_bf16 v97, v87, v7, v97
    v_dot2_f32_bf16 v99, v87, v87, v99
    s_waitcnt lgkmcnt(1)
    v_dot2_f32_bf16 v96, v88, v7, v96
    v_dot2_f32_bf16 v98, v88, v88, v98
    v_dot2_f32_bf16 v97, v89, v7, v97
    v_dot2_f32_bf16 v99, v89, v89, v99
    v_dot2_f32_bf16 v96, v90, v7, v96
    v_dot2_f32_bf16 v98, v90, v90, v98
    v_dot2_f32_bf16 v97, v91, v7, v97
    v_dot2_f32_bf16 v99, v91, v91, v99
    s_waitcnt lgkmcnt(0)
    v_dot2_f32_bf16 v96, v92, v7, v96
    v_dot2_f32_bf16 v98, v92, v92, v98
    v_dot2_f32_bf16 v97, v93, v7, v97
    v_dot2_f32_bf16 v99, v93, v93, v99
    v_dot2_f32_bf16 v96, v94, v7, v96
    v_dot2_f32_bf16 v98, v94, v94, v98
    v_dot2_f32_bf16 v97, v95, v7, v97
    v_dot2_f32_bf16 v99, v95, v95, v99
    s_add_u32 s46, s46, 16384
    s_cmp_eq_u32 s46, 65536
    s_cselect_b32 s46, 0, s46
    s_add_u32 s44, s44, 1
    s_cmp_lt_u32 s44, 10
    s_cbranch_scc1 K1_SL
    s_nop 3
    v_add_f32 v96, v96, v97
    v_add_f32 v97, v98, v99
    v_lshlrev_b32 v16, 3, v15
    v_lshl_add_u32 v16, v20, 8, v16
    s_lshl_b32 s37, s31, 9
    s_add_u32 s37, s37, 147456
    v_add_u32 v16, s37, v16
    ds_write_b64 v16, v[96:97]
    s_waitcnt lgkmcnt(0)
    s_barrier
    s_endpgm
K1_COMP:
    s_nop 1
    s_barrier
    s_and_b32 s31, s30, 1
    s_lshr_b32 s32, s30, 1
    v_mov_b32 v7, 0x3f803f80
    v_lshrrev_b32 v10, 5, v2
    v_bfe_u32 v11, v2, 4, 1
    v_bfe_u32 v12, v2, 2, 2
    v_and_b32 v13, 3, v2
    v_lshl_add_u32 v14, v10, 3, v12
    v_lshlrev_b32 v14, 8, v14
    v_and_b32 v15, 1, v13
    v_lshl_add_u32 v14, v15, 3, v14
    v_add_u32 v14, 65536, v14
    s_lshl_b32 s34, s31, 3
    v_lshlrev_b32 v15, 1, v11
    v_add_u32 v15, s34, v15
    v_lshrrev_b32 v16, 1, v13
    v_add_u32 v15, v15, v16
    v_lshl_add_u32 v15, v12, 2, v15
    v_and_b32 v16, 15, v15
    v_lshl_add_u32 v24, v16, 4, v14
    v_add_u32 v15, 4, v15
    v_and_b32 v16, 15, v15
    v_lshl_add_u32 v25, v16, 4, v14
    v_and_b32 v15, 31, v2
    v_bfe_u32 v16, v2, 1, 3
    v_xor_b32 v16, v16, v10
    v_lshlrev_b32 v17, 7, v15
    s_lshl_b32 s34, s32, 13
    v_add_u32 v17, s34, v17
    v_xor_b32 v34, 0, v16
    v_lshl_add_u32 v26, v34, 4, v17
    v_xor_b32 v34, 2, v16
    v_lshl_add_u32 v27, v34, 4, v17
    v_xor_b32 v34, 4, v16
    v_lshl_add_u32 v28, v34, 4, v17
    v_xor_b32 v34, 6, v16
    v_lshl_add_u32 v29, v34, 4, v17
    v_and_b32 v34, 15, v2
    v_cmp_eq_u32 vcc, v34, v11
    s_nop 1
    v_cndmask_b32 v36, 0, v7, vcc
    v_mov_b32 v37, v36
    v_mov_b32 v38, v36
    v_mov_b32 v39, v36
    s_waitcnt vmcnt(0) lgkmcnt(0)
    v_mov_b32 v72, 0
    v_mov_b32 v73, 0
    v_mov_b32 v74, 0
    v_mov_b32 v75, 0
    v_mov_b32 v76, 0
    v_mov_b32 v77, 0
    v_mov_b32 v78, 0
    v_mov_b32 v79, 0
    v_mov_b32 v80, 0
    v_mov_b32 v81, 0
    v_mov_b32 v82, 0
    v_mov_b32 v83, 0
    v_mov_b32 v84, 0
    v_mov_b32 v85, 0
    v_mov_b32 v86, 0
    v_mov_b32 v87, 0
    v_mov_b32 v88, 0
    v_mov_b32 v89, 0
    v_mov_b32 v90, 0
    v_mov_b32 v91, 0
    v_mov_b32 v92, 0
    v_mov_b32 v93, 0
    v_mov_b32 v94, 0
    v_mov_b32 v95, 0
    v_mov_b32 v96, 0
    v_mov_b32 v97, 0
    v_mov_b32 v98, 0
    v_mov_b32 v99, 0
    v_mov_b32 v100, 0
    v_mov_b32 v101, 0
    v_mov_b32 v102, 0
    v_mov_b32 v103, 0
    v_mov_b32 v104, 0
    v_mov_b32 v105, 0
    v_mov_b32 v106, 0
    v_mov_b32 v107, 0
    v_mov_b32 v108, 0
    v_mov_b32 v109, 0
    v_mov_b32 v110, 0
    v_mov_b32 v111, 0
    v_mov_b32 v112, 0
    v_mov_b32 v113, 0
    v_mov_b32 v114, 0
    v_mov_b32 v115, 0
    v_mov_b32 v116, 0
    v_mov_b32 v117, 0
    v_mov_b32 v118, 0
    v_mov_b32 v119, 0
    v_mov_b32 v120, 0
    v_mov_b32 v121, 0
    v_mov_b32 v122, 0
    v_mov_b32 v123, 0
    v_mov_b32 v124, 0
    v_mov_b32 v125, 0
    v_mov_b32 v126, 0
    v_mov_b32 v127, 0
    v_mov_b32 v128, 0
    v_mov_b32 v129, 0
    v_mov_b32 v130, 0
    v_mov_b32 v131, 0
    v_mov_b32 v132, 0
    v_mov_b32 v133, 0
    v_mov_b32 v134, 0
    v_mov_b32 v135, 0
    v_mov_b32 v136, 0
    v_mov_b32 v137, 0
    v_mov_b32 v138, 0
    v_mov_b32 v139, 0
    v_mov_b32 v140, 0
    v_mov_b32 v141, 0
    v_mov_b32 v142, 0
    v_mov_b32 v143, 0
    v_mov_b32 v144, 0
    v_mov_b32 v145, 0
    v_mov_b32 v146, 0
    v_mov_b32 v147, 0
    v_mov_b32 v148, 0
    v_mov_b32 v149, 0
    v_mov_b32 v150, 0
    v_mov_b32 v151, 0
    v_mov_b32 v152, 0
    v_mov_b32 v153, 0
    v_mov_b32 v154, 0
    v_mov_b32 v155, 0
    v_mov_b32 v156, 0
    v_mov_b32 v157, 0
    v_mov_b32 v158, 0
    v_mov_b32 v159, 0
    v_mov_b32 v160, 0
    v_mov_b32 v161, 0
    v_mov_b32 v162, 0
    v_mov_b32 v163, 0
    v_mov_b32 v164, 0
    v_mov_b32 v165, 0
    v_mov_b32 v166, 0
    v_mov_b32 v167, 0
    v_mov_b32 v4, 0
    v_mov_b32 v5, 0
    v_mov_b32 v6, 0
    v_mov_b32 v7, 0
    v_mov_b32 v32, 0
    v_mov_b32 v33, 0
    v_mov_b32 v34, 0
    v_mov_b32 v35, 0
    s_mov_b32 s24, s10
    s_and_b32 s25, s11, 0xffff
    s_mov_b32 s26, 16777216
    s_mov_b32 s27, 0x00020000
    s_mov_b32 s44, 0
    s_mov_b32 s45, 0
    s_mov_b32 s46, 0
K1_LOOP:
    v_add_u32 v30, s45, v24
    v_add_u32 v31, s45, v25
    v_add_u32 v18, s46, v26
    v_add_u32 v19, s46, v27
    v_add_u32 v20, s46, v28
    v_add_u32 v21, s46, v29
    s_waitcnt lgkmcnt(0)
    s_barrier
    v_mfma_f32_32x32x16_bf16 v[104:119], v[72:75], v[88:91], v[104:119]
    ds_read_b64_tr_b16 v[40:41], v30 offset:0
    ds_read_b64_tr_b16 v[42:43], v30 offset:1024
    v_mfma_f32_32x32x16_bf16 v[120:135], v[72:75], v[92:95], v[120:135]
    ds_read_b64_tr_b16 v[44:45], v31 offset:0
    ds_read_b64_tr_b16 v[46:47], v31 offset:1024
    v_mfma_f32_16x16x32_bf16 v[4:7], v[72:75], v[36:39], v[4:7]
    ds_read_b128 v[56:59], v18 offset:0
    ds_read_b128 v[60:63], v18 offset:4096
    v_mfma_f32_32x32x16_bf16 v[136:151], v[76:79], v[88:91], v[136:151]
    ds_read_b64_tr_b16 v[48:49], v30 offset:4096
    ds_read_b64_tr_b16 v[50:51], v30 offset:5120
    v_mfma_f32_32x32x16_bf16 v[152:167], v[76:79], v[92:95], v[152:167]
    ds_read_b64_tr_b16 v[52:53], v31 offset:4096
    ds_read_b64_tr_b16 v[54:55], v31 offset:5120
    v_mfma_f32_16x16x32_bf16 v[32:35], v[76:79], v[36:39], v[32:35]
    ds_read_b128 v[64:67], v19 offset:0
    ds_read_b128 v[68:71], v19 offset:4096
    v_mfma_f32_32x32x16_bf16 v[104:119], v[80:83], v[96:99], v[104:119]
    v_mfma_f32_32x32x16_bf16 v[120:135], v[80:83], v[100:103], v[120:135]
    v_mfma_f32_16x16x32_bf16 v[4:7], v[80:83], v[36:39], v[4:7]
    v_mfma_f32_32x32x16_bf16 v[136:151], v[84:87], v[96:99], v[136:151]
    v_mfma_f32_32x32x16_bf16 v[152:167], v[84:87], v[100:103], v[152:167]
    v_mfma_f32_16x16x32_bf16 v[32:35], v[84:87], v[36:39], v[32:35]
    s_waitcnt lgkmcnt(0)
    v_mfma_f32_32x32x16_bf16 v[104:119], v[40:43], v[56:59], v[104:119]
    ds_read_b64_tr_b16 v[72:73], v30 offset:8192
    ds_read_b64_tr_b16 v[74:75], v30 offset:9216
    v_mfma_f32_32x32x16_bf16 v[120:135], v[40:43], v[60:63], v[120:135]
    ds_read_b64_tr_b16 v[76:77], v31 offset:8192
    ds_read_b64_tr_b16 v[78:79], v31 offset:9216
    v_mfma_f32_16x16x32_bf16 v[4:7], v[40:43], v[36:39], v[4:7]
    ds_read_b128 v[88:91], v20 offset:0
    ds_read_b128 v[92:95], v20 offset:4096
    v_mfma_f32_32x32x16_bf16 v[136:151], v[44:47], v[56:59], v[136:151]
    ds_read_b64_tr_b16 v[80:81], v30 offset:12288
    ds_read_b64_tr_b16 v[82:83], v30 offset:13312
    v_mfma_f32_32x32x16_bf16 v[152:167], v[44:47], v[60:63], v[152:167]
    ds_read_b64_tr_b16 v[84:85], v31 offset:12288
    ds_read_b64_tr_b16 v[86:87], v31 offset:13312
    v_mfma_f32_16x16x32_bf16 v[32:35], v[44:47], v[36:39], v[32:35]
    ds_read_b128 v[96:99], v21 offset:0
    ds_read_b128 v[100:103], v21 offset:4096
    v_mfma_f32_32x32x16_bf16 v[104:119], v[48:51], v[64:67], v[104:119]
    v_mfma_f32_32x32x16_bf16 v[120:135], v[48:51], v[68:71], v[120:135]
    v_mfma_f32_16x16x32_bf16 v[4:7], v[48:51], v[36:39], v[4:7]
    v_mfma_f32_32x32x16_bf16 v[136:151], v[52:55], v[64:67], v[136:151]
    v_mfma_f32_32x32x16_bf16 v[152:167], v[52:55], v[68:71], v[152:167]
    v_mfma_f32_16x16x32_bf16 v[32:35], v[52:55], v[36:39], v[32:35]
    s_add_u32 s45, s45, 16384
    s_cmp_eq_u32 s45, 81920
    s_cselect_b32 s45, 0, s45
    s_add_u32 s46, s46, 16384
    s_cmp_eq_u32 s46, 65536
    s_cselect_b32 s46, 0, s46
    s_add_u32 s44, s44, 1
    s_cmp_lt_u32 s44, 10
    s_cbranch_scc1 K1_LOOP
    s_waitcnt lgkmcnt(0)
    v_mfma_f32_32x32x16_bf16 v[104:119], v[72:75], v[88:91], v[104:119]
    v_mfma_f32_32x32x16_bf16 v[120:135], v[72:75], v[92:95], v[120:135]
    v_mfma_f32_16x16x32_bf16 v[4:7], v[72:75], v[36:39], v[4:7]
    v_mfma_f32_32x32x16_bf16 v[136:151], v[76:79], v[88:91], v[136:151]
    v_mfma_f32_32x32x16_bf16 v[152:167], v[76:79], v[92:95], v[152:167]
    v_mfma_f32_16x16x32_bf16 v[32:35], v[76:79], v[36:39], v[32:35]
    v_mfma_f32_32x32x16_bf16 v[104:119], v[80:83], v[96:99], v[104:119]
    v_mfma_f32_32x32x16_bf16 v[120:135], v[80:83], v[100:103], v[120:135]
    v_mfma_f32_16x16x32_bf16 v[4:7], v[80:83], v[36:39], v[4:7]
    v_mfma_f32_32x32x16_bf16 v[136:151], v[84:87], v[96:99], v[136:151]
    v_mfma_f32_32x32x16_bf16 v[152:167], v[84:87], v[100:103], v[152:167]
    v_mfma_f32_16x16x32_bf16 v[32:35], v[84:87], v[36:39], v[32:35]
    v_and_b32 v15, 31, v2
    v_and_b32 v8, 15, v2
    v_lshlrev_b32 v17, 6, v8
    v_lshrrev_b32 v9, 4, v2
    v_lshl_add_u32 v17, v9, 4, v17
    v_lshl_add_u32 v17, v1, 8, v17
    v_add_u32 v17, 149504, v17
    v_cmp_gt_u32 vcc, 2, v8
    s_nop 0
    s_and_saveexec_b64 s[38:39], vcc
    ds_write_b128 v17, v[4:7]
    ds_write_b128 v17, v[32:35] offset:128
    s_mov_b64 exec, s[38:39]
    s_waitcnt lgkmcnt(0)
    s_barrier
    v_lshlrev_b32 v16, 3, v15
    s_lshl_b32 s34, s32, 10
    s_add_u32 s34, s34, 147456
    v_add_u32 v16, s34, v16
    ds_read_b64 v[40:41], v16 offset:0
    ds_read_b64 v[42:43], v16 offset:256
    ds_read_b64 v[56:57], v16 offset:512
    ds_read_b64 v[58:59], v16 offset:768
    v_lshlrev_b32 v17, 4, v10
    v_lshl_add_u32 v17, v1, 8, v17
    v_add_u32 v17, 149504, v17
    ds_read_b128 v[72:75], v17 offset:0
    ds_read_b128 v[76:79], v17 offset:32
    ds_read_b128 v[80:83], v17 offset:64
    ds_read_b128 v[84:87], v17 offset:96
    ds_read_b128 v[88:91], v17 offset:128
    ds_read_b128 v[92:95], v17 offset:160
    ds_read_b128 v[96:99], v17 offset:192
    ds_read_b128 v[100:103], v17 offset:224
    s_waitcnt lgkmcnt(0)
    v_add_f32 v40, v40, v42
    v_add_f32 v41, v41, v43
    v_mul_f32 v40, 0x3acccccd, v40
    v_mul_f32 v41, 0x3acccccd, v41
    v_fma_f32 v41, -v40, v40, v41
    v_max_f32 v41, 0, v41
    v_cvt_pk_bf16_f32 v20, 0, v40
    v_cvt_pk_bf16_f32 v41, 0, v41
    v_add_f32 v41, 0x3727c5ac, v41
    v_cvt_pk_bf16_f32 v41, 0, v41
    v_sqrt_f32 v41, v41
    s_nop 0
    v_cvt_pk_bf16_f32 v41, 0, v41
    v_rcp_f32 v22, v41
    s_nop 0
    v_mul_f32 v24, 0x3ea52b5b, v22
    v_add_f32 v56, v56, v58
    v_add_f32 v57, v57, v59
    v_mul_f32 v56, 0x3acccccd, v56
    v_mul_f32 v57, 0x3acccccd, v57
    v_fma_f32 v57, -v56, v56, v57
    v_max_f32 v57, 0, v57
    v_cvt_pk_bf16_f32 v21, 0, v56
    v_cvt_pk_bf16_f32 v57, 0, v57
    v_add_f32 v57, 0x3727c5ac, v57
    v_cvt_pk_bf16_f32 v57, 0, v57
    v_sqrt_f32 v57, v57
    s_nop 0
    v_cvt_pk_bf16_f32 v57, 0, v57
    v_rcp_f32 v23, v57
    s_nop 0
    v_mul_f32 v25, 0x3ea52b5b, v23
    s_lshl_b32 s34, s31, 4
    v_add_u32 v14, s34, v10
    s_lshl_b32 s34, s32, 6
    v_add_u32 v15, s34, v15
    v_mul_u32_u24 v15, 40, v15
    s_mul_i32 s36, s28, 30
    s_sub_i32 s36, 160, s36
    v_add_u32 v16, 0, v14
    v_cmp_gt_i32 vcc, s36, v16
    v_mul_u32_u24 v17, 52429, v16
    v_lshrrev_b32 v17, 18, v17
    v_mul_u32_u24 v18, 5, v17
    v_sub_u32 v18, v16, v18
    v_mul_u32_u24 v17, 5120, v17
    v_lshl_add_u32 v17, v18, 3, v17
    v_add_u32 v17, v17, v15
    v_cndmask_b32 v26, v22, v24, vcc
    v_cndmask_b32 v27, v23, v25, vcc
    v_fma_f32 v104, -v20, v72, v104
    v_mul_f32 v104, v104, v26
    v_fma_f32 v105, -v20, v73, v105
    v_mul_f32 v105, v105, v26
    v_fma_f32 v106, -v20, v74, v106
    v_mul_f32 v106, v106, v26
    v_fma_f32 v107, -v20, v75, v107
    v_mul_f32 v107, v107, v26
    v_cvt_pk_bf16_f32 v40, v104, v105
    v_cvt_pk_bf16_f32 v41, v106, v107
    ds_write_b64 v17, v[40:41] offset:0
    v_fma_f32 v120, -v21, v72, v120
    v_mul_f32 v120, v120, v27
    v_fma_f32 v121, -v21, v73, v121
    v_mul_f32 v121, v121, v27
    v_fma_f32 v122, -v21, v74, v122
    v_mul_f32 v122, v122, v27
    v_fma_f32 v123, -v21, v75, v123
    v_mul_f32 v123, v123, v27
    v_cvt_pk_bf16_f32 v42, v120, v121
    v_cvt_pk_bf16_f32 v43, v122, v123
    ds_write_b64 v17, v[42:43] offset:1280
    v_add_u32 v16, 2, v14
    v_cmp_gt_i32 vcc, s36, v16
    v_mul_u32_u24 v17, 52429, v16
    v_lshrrev_b32 v17, 18, v17
    v_mul_u32_u24 v18, 5, v17
    v_sub_u32 v18, v16, v18
    v_mul_u32_u24 v17, 5120, v17
    v_lshl_add_u32 v17, v18, 3, v17
    v_add_u32 v17, v17, v15
    v_cndmask_b32 v26, v22, v24, vcc
    v_cndmask_b32 v27, v23, v25, vcc
    v_fma_f32 v108, -v20, v76, v108
    v_mul_f32 v108, v108, v26
    v_fma_f32 v109, -v20, v77, v109
    v_mul_f32 v109, v109, v26
    v_fma_f32 v110, -v20, v78, v110
    v_mul_f32 v110, v110, v26
    v_fma_f32 v111, -v20, v79, v111
    v_mul_f32 v111, v111, v26
    v_cvt_pk_bf16_f32 v40, v108, v109
    v_cvt_pk_bf16_f32 v41, v110, v111
    ds_write_b64 v17, v[40:41] offset:0
    v_fma_f32 v124, -v21, v76, v124
    v_mul_f32 v124, v124, v27
    v_fma_f32 v125, -v21, v77, v125
    v_mul_f32 v125, v125, v27
    v_fma_f32 v126, -v21, v78, v126
    v_mul_f32 v126, v126, v27
    v_fma_f32 v127, -v21, v79, v127
    v_mul_f32 v127, v127, v27
    v_cvt_pk_bf16_f32 v42, v124, v125
    v_cvt_pk_bf16_f32 v43, v126, v127
    ds_write_b64 v17, v[42:43] offset:1280
    v_add_u32 v16, 4, v14
    v_cmp_gt_i32 vcc, s36, v16
    v_mul_u32_u24 v17, 52429, v16
    v_lshrrev_b32 v17, 18, v17
    v_mul_u32_u24 v18, 5, v17
    v_sub_u32 v18, v16, v18
    v_mul_u32_u24 v17, 5120, v17
    v_lshl_add_u32 v17, v18, 3, v17
    v_add_u32 v17, v17, v15
    v_cndmask_b32 v26, v22, v24, vcc
    v_cndmask_b32 v27, v23, v25, vcc
    v_fma_f32 v112, -v20, v80, v112
    v_mul_f32 v112, v112, v26
    v_fma_f32 v113, -v20, v81, v113
    v_mul_f32 v113, v113, v26
    v_fma_f32 v114, -v20, v82, v114
    v_mul_f32 v114, v114, v26
    v_fma_f32 v115, -v20, v83, v115
    v_mul_f32 v115, v115, v26
    v_cvt_pk_bf16_f32 v40, v112, v113
    v_cvt_pk_bf16_f32 v41, v114, v115
    ds_write_b64 v17, v[40:41] offset:0
    v_fma_f32 v128, -v21, v80, v128
    v_mul_f32 v128, v128, v27
    v_fma_f32 v129, -v21, v81, v129
    v_mul_f32 v129, v129, v27
    v_fma_f32 v130, -v21, v82, v130
    v_mul_f32 v130, v130, v27
    v_fma_f32 v131, -v21, v83, v131
    v_mul_f32 v131, v131, v27
    v_cvt_pk_bf16_f32 v42, v128, v129
    v_cvt_pk_bf16_f32 v43, v130, v131
    ds_write_b64 v17, v[42:43] offset:1280
    v_add_u32 v16, 6, v14
    v_cmp_gt_i32 vcc, s36, v16
    v_mul_u32_u24 v17, 52429, v16
    v_lshrrev_b32 v17, 18, v17
    v_mul_u32_u24 v18, 5, v17
    v_sub_u32 v18, v16, v18
    v_mul_u32_u24 v17, 5120, v17
    v_lshl_add_u32 v17, v18, 3, v17
    v_add_u32 v17, v17, v15
    v_cndmask_b32 v26, v22, v24, vcc
    v_cndmask_b32 v27, v23, v25, vcc
    v_fma_f32 v116, -v20, v84, v116
    v_mul_f32 v116, v116, v26
    v_fma_f32 v117, -v20, v85, v117
    v_mul_f32 v117, v117, v26
    v_fma_f32 v118, -v20, v86, v118
    v_mul_f32 v118, v118, v26
    v_fma_f32 v119, -v20, v87, v119
    v_mul_f32 v119, v119, v26
    v_cvt_pk_bf16_f32 v40, v116, v117
    v_cvt_pk_bf16_f32 v41, v118, v119
    ds_write_b64 v17, v[40:41] offset:0
    v_fma_f32 v132, -v21, v84, v132
    v_mul_f32 v132, v132, v27
    v_fma_f32 v133, -v21, v85, v133
    v_mul_f32 v133, v133, v27
    v_fma_f32 v134, -v21, v86, v134
    v_mul_f32 v134, v134, v27
    v_fma_f32 v135, -v21, v87, v135
    v_mul_f32 v135, v135, v27
    v_cvt_pk_bf16_f32 v42, v132, v133
    v_cvt_pk_bf16_f32 v43, v134, v135
    ds_write_b64 v17, v[42:43] offset:1280
    v_add_u32 v16, 8, v14
    v_cmp_gt_i32 vcc, s36, v16
    v_mul_u32_u24 v17, 52429, v16
    v_lshrrev_b32 v17, 18, v17
    v_mul_u32_u24 v18, 5, v17
    v_sub_u32 v18, v16, v18
    v_mul_u32_u24 v17, 5120, v17
    v_lshl_add_u32 v17, v18, 3, v17
    v_add_u32 v17, v17, v15
    v_cndmask_b32 v26, v22, v24, vcc
    v_cndmask_b32 v27, v23, v25, vcc
    v_fma_f32 v136, -v20, v88, v136
    v_mul_f32 v136, v136, v26
    v_fma_f32 v137, -v20, v89, v137
    v_mul_f32 v137, v137, v26
    v_fma_f32 v138, -v20, v90, v138
    v_mul_f32 v138, v138, v26
    v_fma_f32 v139, -v20, v91, v139
    v_mul_f32 v139, v139, v26
    v_cvt_pk_bf16_f32 v40, v136, v137
    v_cvt_pk_bf16_f32 v41, v138, v139
    ds_write_b64 v17, v[40:41] offset:0
    v_fma_f32 v152, -v21, v88, v152
    v_mul_f32 v152, v152, v27
    v_fma_f32 v153, -v21, v89, v153
    v_mul_f32 v153, v153, v27
    v_fma_f32 v154, -v21, v90, v154
    v_mul_f32 v154, v154, v27
    v_fma_f32 v155, -v21, v91, v155
    v_mul_f32 v155, v155, v27
    v_cvt_pk_bf16_f32 v42, v152, v153
    v_cvt_pk_bf16_f32 v43, v154, v155
    ds_write_b64 v17, v[42:43] offset:1280
    v_add_u32 v16, 10, v14
    v_cmp_gt_i32 vcc, s36, v16
    v_mul_u32_u24 v17, 52429, v16
    v_lshrrev_b32 v17, 18, v17
    v_mul_u32_u24 v18, 5, v17
    v_sub_u32 v18, v16, v18
    v_mul_u32_u24 v17, 5120, v17
    v_lshl_add_u32 v17, v18, 3, v17
    v_add_u32 v17, v17, v15
    v_cndmask_b32 v26, v22, v24, vcc
    v_cndmask_b32 v27, v23, v25, vcc
    v_fma_f32 v140, -v20, v92, v140
    v_mul_f32 v140, v140, v26
    v_fma_f32 v141, -v20, v93, v141
    v_mul_f32 v141, v141, v26
    v_fma_f32 v142, -v20, v94, v142
    v_mul_f32 v142, v142, v26
    v_fma_f32 v143, -v20, v95, v143
    v_mul_f32 v143, v143, v26
    v_cvt_pk_bf16_f32 v40, v140, v141
    v_cvt_pk_bf16_f32 v41, v142, v143
    ds_write_b64 v17, v[40:41] offset:0
    v_fma_f32 v156, -v21, v92, v156
    v_mul_f32 v156, v156, v27
    v_fma_f32 v157, -v21, v93, v157
    v_mul_f32 v157, v157, v27
    v_fma_f32 v158, -v21, v94, v158
    v_mul_f32 v158, v158, v27
    v_fma_f32 v159, -v21, v95, v159
    v_mul_f32 v159, v159, v27
    v_cvt_pk_bf16_f32 v42, v156, v157
    v_cvt_pk_bf16_f32 v43, v158, v159
    ds_write_b64 v17, v[42:43] offset:1280
    v_add_u32 v16, 12, v14
    v_cmp_gt_i32 vcc, s36, v16
    v_mul_u32_u24 v17, 52429, v16
    v_lshrrev_b32 v17, 18, v17
    v_mul_u32_u24 v18, 5, v17
    v_sub_u32 v18, v16, v18
    v_mul_u32_u24 v17, 5120, v17
    v_lshl_add_u32 v17, v18, 3, v17
    v_add_u32 v17, v17, v15
    v_cndmask_b32 v26, v22, v24, vcc
    v_cndmask_b32 v27, v23, v25, vcc
    v_fma_f32 v144, -v20, v96, v144
    v_mul_f32 v144, v144, v26
    v_fma_f32 v145, -v20, v97, v145
    v_mul_f32 v145, v145, v26
    v_fma_f32 v146, -v20, v98, v146
    v_mul_f32 v146, v146, v26
    v_fma_f32 v147, -v20, v99, v147
    v_mul_f32 v147, v147, v26
    v_cvt_pk_bf16_f32 v40, v144, v145
    v_cvt_pk_bf16_f32 v41, v146, v147
    ds_write_b64 v17, v[40:41] offset:0
    v_fma_f32 v160, -v21, v96, v160
    v_mul_f32 v160, v160, v27
    v_fma_f32 v161, -v21, v97, v161
    v_mul_f32 v161, v161, v27
    v_fma_f32 v162, -v21, v98, v162
    v_mul_f32 v162, v162, v27
    v_fma_f32 v163, -v21, v99, v163
    v_mul_f32 v163, v163, v27
    v_cvt_pk_bf16_f32 v42, v160, v161
    v_cvt_pk_bf16_f32 v43, v162, v163
    ds_write_b64 v17, v[42:43] offset:1280
    s_cmp_eq_u32 s31, 1
    s_cbranch_scc1 K1_COPY
    v_add_u32 v16, 14, v14
    v_cmp_gt_i32 vcc, s36, v16
    v_mul_u32_u24 v17, 52429, v16
    v_lshrrev_b32 v17, 18, v17
    v_mul_u32_u24 v18, 5, v17
    v_sub_u32 v18, v16, v18
    v_mul_u32_u24 v17, 5120, v17
    v_lshl_add_u32 v17, v18, 3, v17
    v_add_u32 v17, v17, v15
    v_cndmask_b32 v26, v22, v24, vcc
    v_cndmask_b32 v27, v23, v25, vcc
    v_fma_f32 v148, -v20, v100, v148
    v_mul_f32 v148, v148, v26
    v_fma_f32 v149, -v20, v101, v149
    v_mul_f32 v149, v149, v26
    v_fma_f32 v150, -v20, v102, v150
    v_mul_f32 v150, v150, v26
    v_fma_f32 v151, -v20, v103, v151
    v_mul_f32 v151, v151, v26
    v_cvt_pk_bf16_f32 v40, v148, v149
    v_cvt_pk_bf16_f32 v41, v150, v151
    ds_write_b64 v17, v[40:41] offset:0
    v_fma_f32 v164, -v21, v100, v164
    v_mul_f32 v164, v164, v27
    v_fma_f32 v165, -v21, v101, v165
    v_mul_f32 v165, v165, v27
    v_fma_f32 v166, -v21, v102, v166
    v_mul_f32 v166, v166, v27
    v_fma_f32 v167, -v21, v103, v167
    v_mul_f32 v167, v167, v27
    v_cvt_pk_bf16_f32 v42, v164, v165
    v_cvt_pk_bf16_f32 v43, v166, v167
    ds_write_b64 v17, v[42:43] offset:1280
K1_COPY:
    s_nop 3
    s_mul_i32 s37, s28, 6
    s_add_u32 s37, s37, s30
    s_lshr_b32 s38, s37, 5
    s_mul_i32 s39, s37, 81920
    s_mul_i32 s40, s30, 5120
    s_lshr_b32 s41, s29, 1
    s_and_b32 s42, s29, 1
    v_lshlrev_b32 v16, 4, v2
    s_cmp_eq_u32 s38, 1
    s_cbranch_scc1 K1_CK
    s_cmp_eq_u32 s38, 2
    s_cbranch_scc1 K1_CV
    v_add_u32 v17, s40, v16
    s_mul_i32 s43, s29, 5120
    s_add_u32 s43, s43, s39
    s_add_u32 s44, s43, 4096
    s_waitcnt lgkmcnt(0)
    s_barrier
    s_cmp_ge_u32 s30, 6
    s_cbranch_scc1 K1_FIN
    ds_read_b128 v[40:43], v17 offset:0
    ds_read_b128 v[44:47], v17 offset:1024
    ds_read_b128 v[48:51], v17 offset:2048
    ds_read_b128 v[52:55], v17 offset:3072
    ds_read_b128 v[56:59], v17 offset:4096
    s_waitcnt lgkmcnt(4)
    buffer_store_dwordx4 v[40:43], v16, s[24:27], s43 offen offset:0 sc0 sc1
    s_waitcnt lgkmcnt(3)
    buffer_store_dwordx4 v[44:47], v16, s[24:27], s43 offen offset:1024 sc0 sc1
    s_waitcnt lgkmcnt(2)
    buffer_store_dwordx4 v[48:51], v16, s[24:27], s43 offen offset:2048 sc0 sc1
    s_waitcnt lgkmcnt(1)
    buffer_store_dwordx4 v[52:55], v16, s[24:27], s43 offen offset:3072 sc0 sc1
    s_waitcnt lgkmcnt(0)
    buffer_store_dwordx4 v[56:59], v16, s[24:27], s44 offen offset:0 sc0 sc1
    s_branch K1_FIN
K1_CK:
    v_lshrrev_b32 v17, 1, v2
    v_mul_u32_u24 v17, 40, v17
    v_and_b32 v18, 1, v2
    v_lshl_add_u32 v17, v18, 4, v17
    v_add_u32 v17, s40, v17
    v_mul_u32_u24 v18, 80, v2
    v_add_u32 v18, s40, v18
    s_mul_i32 s43, s41, 10240
    s_add_u32 s43, s43, s39
    s_lshl_b32 s44, s42, 10
    s_add_u32 s44, s44, s43
    s_add_u32 s44, s44, 8192
    s_lshl_b32 s45, s42, 12
    s_add_u32 s43, s43, s45
    s_waitcnt lgkmcnt(0)
    s_barrier
    s_cmp_ge_u32 s30, 6
    s_cbranch_scc1 K1_FIN
    ds_read_b64 v[40:41], v17 offset:0
    ds_read_b64 v[42:43], v17 offset:8
    ds_read_b64 v[44:45], v17 offset:1280
    ds_read_b64 v[46:47], v17 offset:1288
    ds_read_b64 v[48:49], v17 offset:2560
    ds_read_b64 v[50:51], v17 offset:2568
    ds_read_b64 v[52:53], v17 offset:3840
    ds_read_b64 v[54:55], v17 offset:3848
    ds_read_b64 v[56:57], v18 offset:32
    ds_read_b64 v[58:59], v18 offset:72
    s_waitcnt lgkmcnt(8)
    buffer_store_dwordx4 v[40:43], v16, s[24:27], s43 offen offset:0 sc0 sc1
    s_waitcnt lgkmcnt(6)
    buffer_store_dwordx4 v[44:47], v16, s[24:27], s43 offen offset:1024 sc0 sc1
    s_waitcnt lgkmcnt(4)
    buffer_store_dwordx4 v[48:51], v16, s[24:27], s43 offen offset:2048 sc0 sc1
    s_waitcnt lgkmcnt(2)
    buffer_store_dwordx4 v[52:55], v16, s[24:27], s43 offen offset:3072 sc0 sc1
    s_waitcnt lgkmcnt(0)
    buffer_store_dwordx4 v[56:59], v16, s[24:27], s44 offen offset:0 sc0 sc1
    s_branch K1_FIN
K1_CV:
    v_lshrrev_b32 v19, 5, v2
    v_bfe_u32 v17, v2, 2, 2
    v_lshl_add_u32 v17, v19, 2, v17
    v_mul_u32_u24 v17, 40, v17
    v_bfe_u32 v18, v2, 4, 1
    v_and_b32 v20, 3, v2
    v_lshl_add_u32 v18, v18, 2, v20
    v_min_u32 v18, 4, v18
    v_lshl_add_u32 v17, v18, 3, v17
    v_add_u32 v17, s40, v17
    v_and_b32 v20, 31, v2
    v_mul_u32_u24 v16, 320, v19
    v_lshl_add_u32 v16, v20, 4, v16
    s_mul_i32 s43, s29, 5120
    s_add_u32 s43, s43, s39
    s_add_u32 s44, s43, 2560
    s_waitcnt lgkmcnt(0)
    s_barrier
    s_cmp_ge_u32 s30, 6
    s_cbranch_scc1 K1_FIN
    ds_read_b64_tr_b16 v[40:41], v17 offset:0
    ds_read_b64_tr_b16 v[42:43], v17 offset:320
    ds_read_b64_tr_b16 v[44:45], v17 offset:640
    ds_read_b64_tr_b16 v[46:47], v17 offset:960
    ds_read_b64_tr_b16 v[48:49], v17 offset:1280
    ds_read_b64_tr_b16 v[50:51], v17 offset:1600
    ds_read_b64_tr_b16 v[52:53], v17 offset:1920
    ds_read_b64_tr_b16 v[54:55], v17 offset:2240
    ds_read_b64_tr_b16 v[56:57], v17 offset:2560
    ds_read_b64_tr_b16 v[58:59], v17 offset:2880
    ds_read_b64_tr_b16 v[60:61], v17 offset:3200
    ds_read_b64_tr_b16 v[62:63], v17 offset:3520
    ds_read_b64_tr_b16 v[64:65], v17 offset:3840
    ds_read_b64_tr_b16 v[66:67], v17 offset:4160
    ds_read_b64_tr_b16 v[68:69], v17 offset:4480
    ds_read_b64_tr_b16 v[70:71], v17 offset:4800
    s_mov_b32 s46, 0x000fffff
    s_mov_b32 s47, 0x000fffff
    s_waitcnt lgkmcnt(0)
    s_mov_b64 exec, s[46:47]
    buffer_store_dwordx4 v[40:43], v16, s[24:27], s43 offen offset:0 sc0 sc1
    buffer_store_dwordx4 v[44:47], v16, s[24:27], s43 offen offset:640 sc0 sc1
    buffer_store_dwordx4 v[48:51], v16, s[24:27], s43 offen offset:1280 sc0 sc1
    buffer_store_dwordx4 v[52:55], v16, s[24:27], s43 offen offset:1920 sc0 sc1
    buffer_store_dwordx4 v[56:59], v16, s[24:27], s44 offen offset:0 sc0 sc1
    buffer_store_dwordx4 v[60:63], v16, s[24:27], s44 offen offset:640 sc0 sc1
    buffer_store_dwordx4 v[64:67], v16, s[24:27], s44 offen offset:1280 sc0 sc1
    buffer_store_dwordx4 v[68:71], v16, s[24:27], s44 offen offset:1920 sc0 sc1
    s_mov_b64 exec, -1
K1_FIN:
K1_END:
    s_endpgm
.globl k2_kernel
.p2align 8
.type k2_kernel,@function
k2_kernel:
    s_cmp_ge_u32 s2, 256
    s_cbranch_scc1 K2_END
    s_load_dwordx2 s[10:11], s[0:1], 80
    s_load_dwordx2 s[6:7], s[0:1], 16
    s_load_dwordx2 s[8:9], s[0:1], 0
    s_load_dwordx2 s[52:53], s[0:1], 64
    s_and_b32 s28, s2, 7
    s_lshr_b32 s29, s2, 3
    s_lshr_b32 s30, s29, 3
    s_lshl_b32 s28, s28, 2
    s_add_u32 s28, s28, s30
    s_and_b32 s29, s29, 7
    v_lshrrev_b32 v1, 6, v0
    v_and_b32 v2, 63, v0
    v_readfirstlane_b32 s30, v1
    v_lshrrev_b32 v3, 5, v2
    v_lshlrev_b32 v150, 4, v2
    s_lshr_b32 s54, s28, 3
    s_lshl_b32 s55, s29, 2
    s_add_u32 s54, s54, s55
    s_and_b32 s55, s28, 7
    s_mul_i32 s56, s55, 160
    s_waitcnt lgkmcnt(0)
    s_mov_b32 s24, s10
    s_and_b32 s25, s11, 0xffff
    s_mov_b32 s26, 16777216
    s_mov_b32 s27, 0x00020000
    s_mul_i32 s31, s28, 81920
    s_add_u32 s32, s31, 2621440
    s_mov_b32 s50, 0
    s_cmp_lg_u32 s30, 4
    s_cbranch_scc1 K2_COMP
    s_setprio 3
    s_mov_b32 m0, 0
    s_add_u32 s48, s32, 0
    buffer_load_dwordx4 v150, s[24:27], s48 offen offset:0 lds
    buffer_load_dwordx4 v150, s[24:27], s48 offen offset:1024 lds
    buffer_load_dwordx4 v150, s[24:27], s48 offen offset:2048 lds
    buffer_load_dwordx4 v150, s[24:27], s48 offen offset:3072 lds
    s_mov_b32 m0, 4096
    s_add_u32 s48, s32, 4096
    buffer_load_dwordx4 v150, s[24:27], s48 offen offset:0 lds
    buffer_load_dwordx4 v150, s[24:27], s48 offen offset:1024 lds
    buffer_load_dwordx4 v150, s[24:27], s48 offen offset:2048 lds
    buffer_load_dwordx4 v150, s[24:27], s48 offen offset:3072 lds
    s_mov_b32 m0, 8192
    s_add_u32 s48, s32, 8192
    buffer_load_dwordx4 v150, s[24:27], s48 offen offset:0 lds
    buffer_load_dwordx4 v150, s[24:27], s48 offen offset:1024 lds
    s_mov_b32 m0, 10240
    s_add_u32 s48, s32, 2621440
    buffer_load_dwordx4 v150, s[24:27], s48 offen offset:0 lds
    buffer_load_dwordx4 v150, s[24:27], s48 offen offset:1024 lds
    buffer_load_dwordx4 v150, s[24:27], s48 offen offset:2048 lds
    buffer_load_dwordx4 v150, s[24:27], s48 offen offset:3072 lds
    s_mov_b32 m0, 14336
    s_add_u32 s48, s32, 2625536
    buffer_load_dwordx4 v150, s[24:27], s48 offen offset:0 lds
    buffer_load_dwordx4 v150, s[24:27], s48 offen offset:1024 lds
    buffer_load_dwordx4 v150, s[24:27], s48 offen offset:2048 lds
    buffer_load_dwordx4 v150, s[24:27], s48 offen offset:3072 lds
    s_mov_b32 m0, 18432
    s_add_u32 s48, s32, 2629632
    buffer_load_dwordx4 v150, s[24:27], s48 offen offset:0 lds
    buffer_load_dwordx4 v150, s[24:27], s48 offen offset:1024 lds
    s_branch K2_PROD
K2_COMP:
    v_and_b32 v132, 31, v2
    v_mul_u32_u24 v133, 40, v132
    v_lshl_add_u32 v145, v3, 4, v133
    v_add_u32 v146, 32, v133
    v_lshlrev_b32 v142, 5, v132
    v_lshl_add_u32 v142, v3, 4, v142
    v_lshlrev_b32 v143, 3, v132
    v_add_u32 v143, 8192, v143
    s_lshl_b32 s34, s29, 8
    s_lshl_b32 s35, s30, 6
    s_add_u32 s34, s34, s35
    s_mul_i32 s35, s34, 40
    s_add_u32 s35, s35, s31
    v_mov_b32 v12, 0
    v_mov_b32 v13, 0
    v_mov_b32 v14, 0
    v_mov_b32 v15, 0
    buffer_load_dwordx2 v[4:5], v145, s[24:27], s35 offen offset:0
    buffer_load_dwordx2 v[6:7], v145, s[24:27], s35 offen offset:8
    v_mov_b32 v24, 0
    v_mov_b32 v25, 0
    v_mov_b32 v26, 0
    v_mov_b32 v27, 0
    buffer_load_dwordx2 v[16:17], v145, s[24:27], s35 offen offset:1280
    buffer_load_dwordx2 v[18:19], v145, s[24:27], s35 offen offset:1288
    s_mov_b64 exec, 0xffffffff
    buffer_load_dwordx2 v[12:13], v146, s[24:27], s35 offen offset:0
    buffer_load_dwordx2 v[24:25], v146, s[24:27], s35 offen offset:1280
    s_mov_b64 exec, -1
    s_lshl_b32 s57, s54, 6
    s_lshl_b32 s33, s30, 4
    s_add_u32 s57, s57, s33
    v_and_b32 v134, 15, v2
    v_lshrrev_b32 v135, 4, v2
    v_add_u32 v136, s57, v134
    v_mul_u32_u24 v136, 1280, v136
    v_lshl_add_u32 v214, v135, 3, v136
    v_add_u32 v214, s56, v214
    s_mov_b32 s16, s8
    s_and_b32 s17, s9, 0xffff
    s_mov_b32 s18, 2621440
    s_mov_b32 s19, 0x00020000
    s_mov_b32 s20, s52
    s_and_b32 s21, s53, 0xffff
    s_mov_b32 s22, 2621440
    s_mov_b32 s23, 0x00020000
    v_lshlrev_b32 v215, 3, v134
    s_lshl_b32 s58, s57, 3
    s_add_u32 s58, s58, 9437184
    v_and_b32 v135, 31, v2
    v_mul_u32_u24 v134, 320, v3
    v_lshl_add_u32 v134, v135, 4, v134
    v_add_u32 v134, 10240, v134
    v_mov_b32 v136, 61440
    v_cmp_gt_u32 vcc, 20, v135
    s_nop 1
    v_cndmask_b32 v144, v136, v134, vcc
    v_cndmask_b32 v151, 0, -1, vcc
    v_mov_b32 v132, 0x3f803f80
    v_mov_b32 v133, v132
    v_mov_b32 v134, v132
    v_mov_b32 v135, v132
    v_mov_b32 v34, v132
    v_mov_b32 v35, v132
    v_mov_b32 v42, v132
    v_mov_b32 v43, v132
    v_lshlrev_b32 v136, 4, v0
    v_add_u32 v136, 61440, v136
    ds_write_b128 v136, v[132:135]
    ds_write_b128 v136, v[132:135] offset:4096
    v_lshlrev_b32 v136, 3, v0
    v_add_u32 v136, 69632, v136
    ds_write_b64 v136, v[132:133]
    s_mov_b32 s72, 0
    v_mov_b32 v132, 71680
    v_mov_b32 v133, 0
    ds_write_b32 v132, v133
    s_waitcnt vmcnt(0)
K2_MAIN:
    s_nop 3
    s_mov_b32 s40, 0
    s_mov_b32 s41, 20480
    s_mov_b32 s42, 40960
    v_mov_b32 v100, 0
    v_mov_b32 v101, 0
    v_mov_b32 v102, 0
    v_mov_b32 v103, 0
    v_mov_b32 v104, 0
    v_mov_b32 v105, 0
    v_mov_b32 v106, 0
    v_mov_b32 v107, 0
    v_mov_b32 v108, 0
    v_mov_b32 v109, 0
    v_mov_b32 v110, 0
    v_mov_b32 v111, 0
    v_mov_b32 v112, 0
    v_mov_b32 v113, 0
    v_mov_b32 v114, 0
    v_mov_b32 v115, 0
    v_mov_b32 v116, 0
    v_mov_b32 v117, 0
    v_mov_b32 v118, 0
    v_mov_b32 v119, 0
    v_mov_b32 v120, 0
    v_mov_b32 v121, 0
    v_mov_b32 v122, 0
    v_mov_b32 v123, 0
    v_mov_b32 v124, 0
    v_mov_b32 v125, 0
    v_mov_b32 v126, 0
    v_mov_b32 v127, 0
    v_mov_b32 v128, 0
    v_mov_b32 v129, 0
    v_mov_b32 v130, 0
    v_mov_b32 v131, 0
    v_mov_b32 v92, 0
    v_mov_b32 v93, 0
    v_mov_b32 v94, 0
    v_mov_b32 v95, 0
    v_mov_b32 v96, 0
    v_mov_b32 v97, 0
    v_mov_b32 v98, 0
    v_mov_b32 v99, 0
    v_mov_b32 v44, 0
    v_mov_b32 v45, 0
    v_mov_b32 v46, 0
    v_mov_b32 v47, 0
    v_mov_b32 v48, 0
    v_mov_b32 v49, 0
    v_mov_b32 v50, 0
    v_mov_b32 v51, 0
    s_waitcnt lgkmcnt(0)
    s_barrier
    v_mov_b32 v145, v142
    v_mov_b32 v146, v143
    v_mov_b32 v147, v144
    v_add_u32 v148, 20480, v142
    v_add_u32 v149, 20480, v143
    ds_read_b128 v[28:31], v145 offset:0
    ds_read_b64 v[32:33], v146 offset:0
    s_waitcnt lgkmcnt(0)
    v_mfma_f32_32x32x16_bf16 v[52:67], v[28:31], v[4:7], 0
    v_mfma_f32_32x32x16_bf16 v[52:67], v[32:35], v[12:15], v[52:67]
    s_cmp_lg_u32 s50, 0
    s_cbranch_scc1 K2_SKIPMAX
    v_mfma_f32_32x32x16_bf16 v[68:83], v[28:31], v[16:19], 0
    v_mfma_f32_32x32x16_bf16 v[68:83], v[32:35], v[24:27], v[68:83]
    s_nop 7
    v_max3_f32 v132, v52, v53, v54
    v_max3_f32 v132, v132, v55, v56
    v_max3_f32 v132, v132, v57, v58
    v_max3_f32 v132, v132, v59, v60
    v_max3_f32 v132, v132, v61, v62
    v_max3_f32 v132, v132, v63, v64
    v_max3_f32 v132, v132, v65, v66
    v_max_f32 v132, v132, v67
    v_mov_b32 v133, v132
    s_nop 1
    v_permlane32_swap_b32 v132, v133
    v_max_f32 v132, v132, v133
    v_sub_f32 v140, 0xc2c80000, v132
    v_cvt_pk_bf16_f32 v134, 0, v140
    v_sub_f32 v135, v140, v134
    v_cvt_pk_bf16_f32 v136, 0, v135
    v_sub_f32 v135, v135, v136
    s_mov_b64 exec, 0xffffffff
    v_cvt_pk_bf16_f32 v14, v134, v136
    v_cvt_pk_bf16_f32 v15, v135, 0
    s_mov_b64 exec, -1
    v_max3_f32 v132, v68, v69, v70
    v_max3_f32 v132, v132, v71, v72
    v_max3_f32 v132, v132, v73, v74
    v_max3_f32 v132, v132, v75, v76
    v_max3_f32 v132, v132, v77, v78
    v_max3_f32 v132, v132, v79, v80
    v_max3_f32 v132, v132, v81, v82
    v_max_f32 v132, v132, v83
    v_mov_b32 v133, v132
    s_nop 1
    v_permlane32_swap_b32 v132, v133
    v_max_f32 v132, v132, v133
    v_sub_f32 v141, 0xc2c80000, v132
    v_cvt_pk_bf16_f32 v134, 0, v141
    v_sub_f32 v135, v141, v134
    v_cvt_pk_bf16_f32 v136, 0, v135
    v_sub_f32 v135, v135, v136
    s_mov_b64 exec, 0xffffffff
    v_cvt_pk_bf16_f32 v26, v134, v136
    v_cvt_pk_bf16_f32 v27, v135, 0
    s_mov_b64 exec, -1
    v_add_f32 v52, v52, v140
    v_add_f32 v53, v53, v140
    v_add_f32 v54, v54, v140
    v_add_f32 v55, v55, v140
    v_add_f32 v56, v56, v140
    v_add_f32 v57, v57, v140
    v_add_f32 v58, v58, v140
    v_add_f32 v59, v59, v140
    v_add_f32 v60, v60, v140
    v_add_f32 v61, v61, v140
    v_add_f32 v62, v62, v140
    v_add_f32 v63, v63, v140
    v_add_f32 v64, v64, v140
    v_add_f32 v65, v65, v140
    v_add_f32 v66, v66, v140
    v_add_f32 v67, v67, v140
    buffer_load_dwordx2 v[192:193], v214, s[16:19], 0 offen offset:0
    buffer_load_dwordx2 v[194:195], v214, s[16:19], 0 offen offset:32
    buffer_load_dwordx2 v[196:197], v214, s[16:19], 0 offen offset:64
    buffer_load_dwordx2 v[198:199], v214, s[16:19], 0 offen offset:96
    buffer_load_dwordx2 v[200:201], v214, s[16:19], 0 offen offset:128
    buffer_load_dwordx2 v[212:213], v215, s[24:27], s58 offen
K2_SKIPMAX:
    s_nop 15
    s_mov_b32 s44, 0
    s_mov_b64 vcc, 0
K2_LOOP:
    s_cbranch_vccnz K2_RC0
K2_NR0:
    v_exp_f32 v52, v52
    ds_read_b128 v[36:39], v145 offset:1024
    ds_read_b64 v[40:41], v146 offset:256
    v_mfma_f32_32x32x16_bf16 v[68:83], v[28:31], v[16:19], 0
    v_exp_f32 v53, v53
    v_exp_f32 v54, v54
    v_exp_f32 v55, v55
    v_cvt_pk_bf16_f32 v84, v52, v53
    v_exp_f32 v56, v56
    v_exp_f32 v57, v57
    v_mfma_f32_32x32x16_bf16 v[68:83], v[32:35], v[24:27], v[68:83]
    v_cvt_pk_bf16_f32 v85, v54, v55
    v_exp_f32 v58, v58
    v_exp_f32 v59, v59
    v_cvt_pk_bf16_f32 v86, v56, v57
    v_exp_f32 v60, v60
    v_exp_f32 v61, v61
    v_mfma_f32_32x32x16_bf16 v[116:131], v[44:47], v[92:95], v[116:131]
    v_cvt_pk_bf16_f32 v87, v58, v59
    v_exp_f32 v62, v62
    v_exp_f32 v63, v63
    v_cvt_pk_bf16_f32 v88, v60, v61
    v_exp_f32 v64, v64
    v_exp_f32 v65, v65
    v_mfma_f32_32x32x16_bf16 v[116:131], v[48:51], v[96:99], v[116:131]
    ds_read_b128 v[44:47], v147 offset:0
    ds_read_b128 v[48:51], v147 offset:640
    v_cvt_pk_bf16_f32 v89, v62, v63
    v_exp_f32 v66, v66
    v_exp_f32 v67, v67
    v_cvt_pk_bf16_f32 v90, v64, v65
    v_cvt_pk_bf16_f32 v91, v66, v67
    v_exp_f32 v68, v68
    s_waitcnt lgkmcnt(2)
    v_mfma_f32_32x32x16_bf16 v[52:67], v[36:39], v[4:7], 0
    v_exp_f32 v69, v69
    v_exp_f32 v70, v70
    v_exp_f32 v71, v71
    v_cvt_pk_bf16_f32 v92, v68, v69
    v_exp_f32 v72, v72
    v_exp_f32 v73, v73
    v_mfma_f32_32x32x16_bf16 v[52:67], v[40:43], v[12:15], v[52:67]
    v_cvt_pk_bf16_f32 v93, v70, v71
    v_exp_f32 v74, v74
    v_exp_f32 v75, v75
    v_cvt_pk_bf16_f32 v94, v72, v73
    v_exp_f32 v76, v76
    v_exp_f32 v77, v77
    s_waitcnt lgkmcnt(0)
    v_mfma_f32_32x32x16_bf16 v[100:115], v[44:47], v[84:87], v[100:115]
    v_cvt_pk_bf16_f32 v95, v74, v75
    v_exp_f32 v78, v78
    v_exp_f32 v79, v79
    v_cvt_pk_bf16_f32 v96, v76, v77
    v_exp_f32 v80, v80
    v_exp_f32 v81, v81
    v_mfma_f32_32x32x16_bf16 v[100:115], v[48:51], v[88:91], v[100:115]
    v_cvt_pk_bf16_f32 v97, v78, v79
    v_exp_f32 v82, v82
    v_exp_f32 v83, v83
    v_cvt_pk_bf16_f32 v98, v80, v81
    v_cvt_pk_bf16_f32 v99, v82, v83
    v_exp_f32 v52, v52
    ds_read_b128 v[28:31], v145 offset:2048
    ds_read_b64 v[32:33], v146 offset:512
    v_mfma_f32_32x32x16_bf16 v[68:83], v[36:39], v[16:19], 0
    v_exp_f32 v53, v53
    v_exp_f32 v54, v54
    v_exp_f32 v55, v55
    v_cvt_pk_bf16_f32 v84, v52, v53
    v_exp_f32 v56, v56
    v_exp_f32 v57, v57
    v_mfma_f32_32x32x16_bf16 v[68:83], v[40:43], v[24:27], v[68:83]
    v_cvt_pk_bf16_f32 v85, v54, v55
    v_exp_f32 v58, v58
    v_exp_f32 v59, v59
    v_cvt_pk_bf16_f32 v86, v56, v57
    v_exp_f32 v60, v60
    v_exp_f32 v61, v61
    v_mfma_f32_32x32x16_bf16 v[116:131], v[44:47], v[92:95], v[116:131]
    v_cvt_pk_bf16_f32 v87, v58, v59
    v_exp_f32 v62, v62
    v_exp_f32 v63, v63
    v_cvt_pk_bf16_f32 v88, v60, v61
    v_exp_f32 v64, v64
    v_exp_f32 v65, v65
    v_mfma_f32_32x32x16_bf16 v[116:131], v[48:51], v[96:99], v[116:131]
    ds_read_b128 v[44:47], v147 offset:1280
    ds_read_b128 v[48:51], v147 offset:1920
    v_cvt_pk_bf16_f32 v89, v62, v63
    v_exp_f32 v66, v66
    v_exp_f32 v67, v67
    v_cvt_pk_bf16_f32 v90, v64, v65
    v_cvt_pk_bf16_f32 v91, v66, v67
    v_exp_f32 v68, v68
    s_waitcnt lgkmcnt(2)
    v_mfma_f32_32x32x16_bf16 v[52:67], v[28:31], v[4:7], 0
    v_exp_f32 v69, v69
    v_exp_f32 v70, v70
    v_exp_f32 v71, v71
    v_cvt_pk_bf16_f32 v92, v68, v69
    v_exp_f32 v72, v72
    v_exp_f32 v73, v73
    v_mfma_f32_32x32x16_bf16 v[52:67], v[32:35], v[12:15], v[52:67]
    v_cvt_pk_bf16_f32 v93, v70, v71
    v_exp_f32 v74, v74
    v_exp_f32 v75, v75
    v_cvt_pk_bf16_f32 v94, v72, v73
    v_exp_f32 v76, v76
    v_exp_f32 v77, v77
    s_waitcnt lgkmcnt(0)
    v_mfma_f32_32x32x16_bf16 v[100:115], v[44:47], v[84:87], v[100:115]
    v_cvt_pk_bf16_f32 v95, v74, v75
    v_exp_f32 v78, v78
    v_exp_f32 v79, v79
    v_cvt_pk_bf16_f32 v96, v76, v77
    v_exp_f32 v80, v80
    v_exp_f32 v81, v81
    v_mfma_f32_32x32x16_bf16 v[100:115], v[48:51], v[88:91], v[100:115]
    v_cvt_pk_bf16_f32 v97, v78, v79
    v_exp_f32 v82, v82
    v_exp_f32 v83, v83
    v_cvt_pk_bf16_f32 v98, v80, v81
    v_cvt_pk_bf16_f32 v99, v82, v83
    v_exp_f32 v52, v52
    ds_read_b128 v[36:39], v145 offset:3072
    ds_read_b64 v[40:41], v146 offset:768
    v_mfma_f32_32x32x16_bf16 v[68:83], v[28:31], v[16:19], 0
    v_exp_f32 v53, v53
    v_exp_f32 v54, v54
    v_exp_f32 v55, v55
    v_cvt_pk_bf16_f32 v84, v52, v53
    v_exp_f32 v56, v56
    v_exp_f32 v57, v57
    v_mfma_f32_32x32x16_bf16 v[68:83], v[32:35], v[24:27], v[68:83]
    v_cvt_pk_bf16_f32 v85, v54, v55
    v_exp_f32 v58, v58
    v_exp_f32 v59, v59
    v_cvt_pk_bf16_f32 v86, v56, v57
    v_exp_f32 v60, v60
    v_exp_f32 v61, v61
    v_mfma_f32_32x32x16_bf16 v[116:131], v[44:47], v[92:95], v[116:131]
    v_cvt_pk_bf16_f32 v87, v58, v59
    v_exp_f32 v62, v62
    v_exp_f32 v63, v63
    v_cvt_pk_bf16_f32 v88, v60, v61
    v_exp_f32 v64, v64
    v_exp_f32 v65, v65
    v_mfma_f32_32x32x16_bf16 v[116:131], v[48:51], v[96:99], v[116:131]
    ds_read_b128 v[44:47], v147 offset:2560
    ds_read_b128 v[48:51], v147 offset:3200
    v_cvt_pk_bf16_f32 v89, v62, v63
    v_exp_f32 v66, v66
    v_exp_f32 v67, v67
    v_cvt_pk_bf16_f32 v90, v64, v65
    v_cvt_pk_bf16_f32 v91, v66, v67
    v_exp_f32 v68, v68
    s_waitcnt lgkmcnt(2)
    v_mfma_f32_32x32x16_bf16 v[52:67], v[36:39], v[4:7], 0
    v_exp_f32 v69, v69
    v_exp_f32 v70, v70
    v_exp_f32 v71, v71
    v_cvt_pk_bf16_f32 v92, v68, v69
    v_exp_f32 v72, v72
    v_exp_f32 v73, v73
    v_mfma_f32_32x32x16_bf16 v[52:67], v[40:43], v[12:15], v[52:67]
    v_cvt_pk_bf16_f32 v93, v70, v71
    v_exp_f32 v74, v74
    v_exp_f32 v75, v75
    v_cvt_pk_bf16_f32 v94, v72, v73
    v_exp_f32 v76, v76
    v_exp_f32 v77, v77
    s_waitcnt lgkmcnt(0)
    v_mfma_f32_32x32x16_bf16 v[100:115], v[44:47], v[84:87], v[100:115]
    v_cvt_pk_bf16_f32 v95, v74, v75
    v_exp_f32 v78, v78
    v_exp_f32 v79, v79
    v_cvt_pk_bf16_f32 v96, v76, v77
    v_exp_f32 v80, v80
    v_exp_f32 v81, v81
    v_mfma_f32_32x32x16_bf16 v[100:115], v[48:51], v[88:91], v[100:115]
    v_cvt_pk_bf16_f32 v97, v78, v79
    v_exp_f32 v82, v82
    v_exp_f32 v83, v83
    v_cvt_pk_bf16_f32 v98, v80, v81
    v_cvt_pk_bf16_f32 v99, v82, v83
    v_exp_f32 v52, v52
    ds_read_b128 v[28:31], v145 offset:4096
    ds_read_b64 v[32:33], v146 offset:1024
    v_mfma_f32_32x32x16_bf16 v[68:83], v[36:39], v[16:19], 0
    v_exp_f32 v53, v53
    v_exp_f32 v54, v54
    v_exp_f32 v55, v55
    v_cvt_pk_bf16_f32 v84, v52, v53
    v_exp_f32 v56, v56
    v_exp_f32 v57, v57
    v_mfma_f32_32x32x16_bf16 v[68:83], v[40:43], v[24:27], v[68:83]
    v_cvt_pk_bf16_f32 v85, v54, v55
    v_exp_f32 v58, v58
    v_exp_f32 v59, v59
    v_cvt_pk_bf16_f32 v86, v56, v57
    v_exp_f32 v60, v60
    v_exp_f32 v61, v61
    v_mfma_f32_32x32x16_bf16 v[116:131], v[44:47], v[92:95], v[116:131]
    v_cvt_pk_bf16_f32 v87, v58, v59
    v_exp_f32 v62, v62
    v_exp_f32 v63, v63
    v_cvt_pk_bf16_f32 v88, v60, v61
    v_exp_f32 v64, v64
    v_exp_f32 v65, v65
    v_mfma_f32_32x32x16_bf16 v[116:131], v[48:51], v[96:99], v[116:131]
    ds_read_b128 v[44:47], v147 offset:3840
    ds_read_b128 v[48:51], v147 offset:4480
    v_cvt_pk_bf16_f32 v89, v62, v63
    v_exp_f32 v66, v66
    v_exp_f32 v67, v67
    v_cvt_pk_bf16_f32 v90, v64, v65
    v_cvt_pk_bf16_f32 v91, v66, v67
    v_exp_f32 v68, v68
    s_waitcnt lgkmcnt(2)
    v_mfma_f32_32x32x16_bf16 v[52:67], v[28:31], v[4:7], 0
    v_exp_f32 v69, v69
    v_exp_f32 v70, v70
    v_exp_f32 v71, v71
    v_cvt_pk_bf16_f32 v92, v68, v69
    v_exp_f32 v72, v72
    v_exp_f32 v73, v73
    v_mfma_f32_32x32x16_bf16 v[52:67], v[32:35], v[12:15], v[52:67]
    v_cvt_pk_bf16_f32 v93, v70, v71
    v_max_f32 v132, v112, v128
    v_cmp_lt_f32 vcc, 0x3f800000, v132
    v_exp_f32 v74, v74
    v_exp_f32 v75, v75
    v_cvt_pk_bf16_f32 v94, v72, v73
    v_exp_f32 v76, v76
    v_exp_f32 v77, v77
    s_waitcnt lgkmcnt(0)
    v_mfma_f32_32x32x16_bf16 v[100:115], v[44:47], v[84:87], v[100:115]
    v_cvt_pk_bf16_f32 v95, v74, v75
    v_exp_f32 v78, v78
    v_exp_f32 v79, v79
    v_cvt_pk_bf16_f32 v96, v76, v77
    v_exp_f32 v80, v80
    v_exp_f32 v81, v81
    v_mfma_f32_32x32x16_bf16 v[100:115], v[48:51], v[88:91], v[100:115]
    v_cvt_pk_bf16_f32 v97, v78, v79
    v_exp_f32 v82, v82
    v_exp_f32 v83, v83
    v_cvt_pk_bf16_f32 v98, v80, v81
    v_cvt_pk_bf16_f32 v99, v82, v83
    s_cbranch_vccnz K2_RC4
K2_NR4:
    v_exp_f32 v52, v52
    ds_read_b128 v[36:39], v145 offset:5120
    ds_read_b64 v[40:41], v146 offset:1280
    v_mfma_f32_32x32x16_bf16 v[68:83], v[28:31], v[16:19], 0
    v_exp_f32 v53, v53
    v_exp_f32 v54, v54
    v_exp_f32 v55, v55
    v_cvt_pk_bf16_f32 v84, v52, v53
    v_exp_f32 v56, v56
    v_exp_f32 v57, v57
    v_mfma_f32_32x32x16_bf16 v[68:83], v[32:35], v[24:27], v[68:83]
    v_cvt_pk_bf16_f32 v85, v54, v55
    v_exp_f32 v58, v58
    v_exp_f32 v59, v59
    v_cvt_pk_bf16_f32 v86, v56, v57
    v_exp_f32 v60, v60
    v_exp_f32 v61, v61
    v_mfma_f32_32x32x16_bf16 v[116:131], v[44:47], v[92:95], v[116:131]
    v_cvt_pk_bf16_f32 v87, v58, v59
    v_exp_f32 v62, v62
    v_exp_f32 v63, v63
    v_cvt_pk_bf16_f32 v88, v60, v61
    v_exp_f32 v64, v64
    v_exp_f32 v65, v65
    v_mfma_f32_32x32x16_bf16 v[116:131], v[48:51], v[96:99], v[116:131]
    ds_read_b128 v[44:47], v147 offset:5120
    ds_read_b128 v[48:51], v147 offset:5760
    v_cvt_pk_bf16_f32 v89, v62, v63
    v_exp_f32 v66, v66
    v_exp_f32 v67, v67
    v_cvt_pk_bf16_f32 v90, v64, v65
    v_cvt_pk_bf16_f32 v91, v66, v67
    v_exp_f32 v68, v68
    s_waitcnt lgkmcnt(2)
    v_mfma_f32_32x32x16_bf16 v[52:67], v[36:39], v[4:7], 0
    v_exp_f32 v69, v69
    v_exp_f32 v70, v70
    v_exp_f32 v71, v71
    v_cvt_pk_bf16_f32 v92, v68, v69
    v_exp_f32 v72, v72
    v_exp_f32 v73, v73
    v_mfma_f32_32x32x16_bf16 v[52:67], v[40:43], v[12:15], v[52:67]
    v_cvt_pk_bf16_f32 v93, v70, v71
    v_exp_f32 v74, v74
    v_exp_f32 v75, v75
    v_cvt_pk_bf16_f32 v94, v72, v73
    v_exp_f32 v76, v76
    v_exp_f32 v77, v77
    s_waitcnt lgkmcnt(0)
    v_mfma_f32_32x32x16_bf16 v[100:115], v[44:47], v[84:87], v[100:115]
    v_cvt_pk_bf16_f32 v95, v74, v75
    v_exp_f32 v78, v78
    v_exp_f32 v79, v79
    v_cvt_pk_bf16_f32 v96, v76, v77
    v_exp_f32 v80, v80
    v_exp_f32 v81, v81
    v_mfma_f32_32x32x16_bf16 v[100:115], v[48:51], v[88:91], v[100:115]
    v_cvt_pk_bf16_f32 v97, v78, v79
    v_exp_f32 v82, v82
    v_exp_f32 v83, v83
    v_cvt_pk_bf16_f32 v98, v80, v81
    v_cvt_pk_bf16_f32 v99, v82, v83
    v_exp_f32 v52, v52
    ds_read_b128 v[28:31], v145 offset:6144
    ds_read_b64 v[32:33], v146 offset:1536
    v_mfma_f32_32x32x16_bf16 v[68:83], v[36:39], v[16:19], 0
    v_exp_f32 v53, v53
    v_exp_f32 v54, v54
    v_exp_f32 v55, v55
    v_cvt_pk_bf16_f32 v84, v52, v53
    v_exp_f32 v56, v56
    v_exp_f32 v57, v57
    v_mfma_f32_32x32x16_bf16 v[68:83], v[40:43], v[24:27], v[68:83]
    v_cvt_pk_bf16_f32 v85, v54, v55
    v_exp_f32 v58, v58
    v_exp_f32 v59, v59
    v_cvt_pk_bf16_f32 v86, v56, v57
    v_exp_f32 v60, v60
    v_exp_f32 v61, v61
    v_mfma_f32_32x32x16_bf16 v[116:131], v[44:47], v[92:95], v[116:131]
    v_cvt_pk_bf16_f32 v87, v58, v59
    v_exp_f32 v62, v62
    v_exp_f32 v63, v63
    v_cvt_pk_bf16_f32 v88, v60, v61
    v_exp_f32 v64, v64
    v_exp_f32 v65, v65
    v_mfma_f32_32x32x16_bf16 v[116:131], v[48:51], v[96:99], v[116:131]
    ds_read_b128 v[44:47], v147 offset:6400
    ds_read_b128 v[48:51], v147 offset:7040
    v_cvt_pk_bf16_f32 v89, v62, v63
    v_exp_f32 v66, v66
    v_exp_f32 v67, v67
    v_cvt_pk_bf16_f32 v90, v64, v65
    v_cvt_pk_bf16_f32 v91, v66, v67
    v_exp_f32 v68, v68
    s_waitcnt lgkmcnt(2)
    v_mfma_f32_32x32x16_bf16 v[52:67], v[28:31], v[4:7], 0
    v_exp_f32 v69, v69
    v_exp_f32 v70, v70
    v_exp_f32 v71, v71
    v_cvt_pk_bf16_f32 v92, v68, v69
    v_exp_f32 v72, v72
    v_exp_f32 v73, v73
    v_mfma_f32_32x32x16_bf16 v[52:67], v[32:35], v[12:15], v[52:67]
    v_cvt_pk_bf16_f32 v93, v70, v71
    v_exp_f32 v74, v74
    v_exp_f32 v75, v75
    v_cvt_pk_bf16_f32 v94, v72, v73
    v_exp_f32 v76, v76
    v_exp_f32 v77, v77
    s_waitcnt lgkmcnt(0)
    v_mfma_f32_32x32x16_bf16 v[100:115], v[44:47], v[84:87], v[100:115]
    v_cvt_pk_bf16_f32 v95, v74, v75
    v_exp_f32 v78, v78
    v_exp_f32 v79, v79
    v_cvt_pk_bf16_f32 v96, v76, v77
    v_exp_f32 v80, v80
    v_exp_f32 v81, v81
    v_mfma_f32_32x32x16_bf16 v[100:115], v[48:51], v[88:91], v[100:115]
    v_cvt_pk_bf16_f32 v97, v78, v79
    v_exp_f32 v82, v82
    v_exp_f32 v83, v83
    v_cvt_pk_bf16_f32 v98, v80, v81
    v_cvt_pk_bf16_f32 v99, v82, v83
    v_exp_f32 v52, v52
    ds_read_b128 v[36:39], v145 offset:7168
    ds_read_b64 v[40:41], v146 offset:1792
    v_mfma_f32_32x32x16_bf16 v[68:83], v[28:31], v[16:19], 0
    v_exp_f32 v53, v53
    v_exp_f32 v54, v54
    v_exp_f32 v55, v55
    v_cvt_pk_bf16_f32 v84, v52, v53
    v_exp_f32 v56, v56
    v_exp_f32 v57, v57
    v_mfma_f32_32x32x16_bf16 v[68:83], v[32:35], v[24:27], v[68:83]
    v_cvt_pk_bf16_f32 v85, v54, v55
    v_exp_f32 v58, v58
    v_exp_f32 v59, v59
    v_cvt_pk_bf16_f32 v86, v56, v57
    v_exp_f32 v60, v60
    v_exp_f32 v61, v61
    v_mfma_f32_32x32x16_bf16 v[116:131], v[44:47], v[92:95], v[116:131]
    v_cvt_pk_bf16_f32 v87, v58, v59
    v_exp_f32 v62, v62
    v_exp_f32 v63, v63
    v_cvt_pk_bf16_f32 v88, v60, v61
    v_exp_f32 v64, v64
    v_exp_f32 v65, v65
    v_mfma_f32_32x32x16_bf16 v[116:131], v[48:51], v[96:99], v[116:131]
    ds_read_b128 v[44:47], v147 offset:7680
    ds_read_b128 v[48:51], v147 offset:8320
    v_cvt_pk_bf16_f32 v89, v62, v63
    v_exp_f32 v66, v66
    v_exp_f32 v67, v67
    v_cvt_pk_bf16_f32 v90, v64, v65
    v_cvt_pk_bf16_f32 v91, v66, v67
    v_exp_f32 v68, v68
    s_waitcnt lgkmcnt(2)
    v_mfma_f32_32x32x16_bf16 v[52:67], v[36:39], v[4:7], 0
    v_exp_f32 v69, v69
    v_exp_f32 v70, v70
    v_exp_f32 v71, v71
    v_cvt_pk_bf16_f32 v92, v68, v69
    v_exp_f32 v72, v72
    v_exp_f32 v73, v73
    v_mfma_f32_32x32x16_bf16 v[52:67], v[40:43], v[12:15], v[52:67]
    v_cvt_pk_bf16_f32 v93, v70, v71
    v_exp_f32 v74, v74
    v_exp_f32 v75, v75
    v_cvt_pk_bf16_f32 v94, v72, v73
    v_exp_f32 v76, v76
    v_exp_f32 v77, v77
    s_waitcnt lgkmcnt(0)
    v_mfma_f32_32x32x16_bf16 v[100:115], v[44:47], v[84:87], v[100:115]
    v_cvt_pk_bf16_f32 v95, v74, v75
    v_exp_f32 v78, v78
    v_exp_f32 v79, v79
    v_cvt_pk_bf16_f32 v96, v76, v77
    v_exp_f32 v80, v80
    v_exp_f32 v81, v81
    v_mfma_f32_32x32x16_bf16 v[100:115], v[48:51], v[88:91], v[100:115]
    v_cvt_pk_bf16_f32 v97, v78, v79
    v_exp_f32 v82, v82
    v_exp_f32 v83, v83
    v_cvt_pk_bf16_f32 v98, v80, v81
    v_cvt_pk_bf16_f32 v99, v82, v83
    s_barrier
    v_exp_f32 v52, v52
    ds_read_b128 v[28:31], v148 offset:0
    ds_read_b64 v[32:33], v149 offset:0
    v_mfma_f32_32x32x16_bf16 v[68:83], v[36:39], v[16:19], 0
    v_exp_f32 v53, v53
    v_exp_f32 v54, v54
    v_exp_f32 v55, v55
    v_cvt_pk_bf16_f32 v84, v52, v53
    v_exp_f32 v56, v56
    v_exp_f32 v57, v57
    v_mfma_f32_32x32x16_bf16 v[68:83], v[40:43], v[24:27], v[68:83]
    v_cvt_pk_bf16_f32 v85, v54, v55
    v_exp_f32 v58, v58
    v_exp_f32 v59, v59
    v_cvt_pk_bf16_f32 v86, v56, v57
    v_exp_f32 v60, v60
    v_exp_f32 v61, v61
    v_mfma_f32_32x32x16_bf16 v[116:131], v[44:47], v[92:95], v[116:131]
    v_cvt_pk_bf16_f32 v87, v58, v59
    v_exp_f32 v62, v62
    v_exp_f32 v63, v63
    v_cvt_pk_bf16_f32 v88, v60, v61
    v_exp_f32 v64, v64
    v_exp_f32 v65, v65
    v_mfma_f32_32x32x16_bf16 v[116:131], v[48:51], v[96:99], v[116:131]
    ds_read_b128 v[44:47], v147 offset:8960
    ds_read_b128 v[48:51], v147 offset:9600
    v_cvt_pk_bf16_f32 v89, v62, v63
    v_exp_f32 v66, v66
    v_exp_f32 v67, v67
    v_cvt_pk_bf16_f32 v90, v64, v65
    v_cvt_pk_bf16_f32 v91, v66, v67
    v_exp_f32 v68, v68
    s_waitcnt lgkmcnt(2)
    v_mfma_f32_32x32x16_bf16 v[52:67], v[28:31], v[4:7], 0
    v_exp_f32 v69, v69
    v_exp_f32 v70, v70
    v_exp_f32 v71, v71
    v_cvt_pk_bf16_f32 v92, v68, v69
    v_exp_f32 v72, v72
    v_exp_f32 v73, v73
    v_mfma_f32_32x32x16_bf16 v[52:67], v[32:35], v[12:15], v[52:67]
    v_cvt_pk_bf16_f32 v93, v70, v71
    v_max_f32 v132, v112, v128
    v_cmp_lt_f32 vcc, 0x3f800000, v132
    v_exp_f32 v74, v74
    v_exp_f32 v75, v75
    v_cvt_pk_bf16_f32 v94, v72, v73
    v_exp_f32 v76, v76
    v_exp_f32 v77, v77
    s_waitcnt lgkmcnt(0)
    v_mfma_f32_32x32x16_bf16 v[100:115], v[44:47], v[84:87], v[100:115]
    v_cvt_pk_bf16_f32 v95, v74, v75
    v_exp_f32 v78, v78
    v_exp_f32 v79, v79
    v_cvt_pk_bf16_f32 v96, v76, v77
    v_exp_f32 v80, v80
    v_exp_f32 v81, v81
    v_mfma_f32_32x32x16_bf16 v[100:115], v[48:51], v[88:91], v[100:115]
    v_cvt_pk_bf16_f32 v97, v78, v79
    v_exp_f32 v82, v82
    v_exp_f32 v83, v83
    v_cvt_pk_bf16_f32 v98, v80, v81
    v_cvt_pk_bf16_f32 v99, v82, v83
    s_mov_b32 s45, s40
    s_mov_b32 s40, s41
    s_mov_b32 s41, s42
    s_mov_b32 s42, s45
    v_add_u32 v145, s40, v142
    v_add_u32 v146, s40, v143
    v_and_b32 v147, s40, v151
    v_add_u32 v147, v147, v144
    v_add_u32 v148, s41, v142
    v_add_u32 v149, s41, v143
    s_add_u32 s44, s44, 1
    s_cmp_lt_u32 s44, 8
    s_cbranch_scc1 K2_LOOP
    v_mfma_f32_32x32x16_bf16 v[116:131], v[44:47], v[92:95], v[116:131]
    v_mfma_f32_32x32x16_bf16 v[116:131], v[48:51], v[96:99], v[116:131]
    s_waitcnt lgkmcnt(0)
    s_cmp_lg_u32 s50, 0
    s_cbranch_scc1 K2_EPI
    v_mul_f32 v132, 0, v100
    v_fma_f32 v132, v101, 0, v132
    v_fma_f32 v132, v102, 0, v132
    v_fma_f32 v132, v103, 0, v132
    v_fma_f32 v132, v104, 0, v132
    v_fma_f32 v132, v105, 0, v132
    v_fma_f32 v132, v106, 0, v132
    v_fma_f32 v132, v107, 0, v132
    v_fma_f32 v132, v108, 0, v132
    v_fma_f32 v132, v109, 0, v132
    v_fma_f32 v132, v110, 0, v132
    v_fma_f32 v132, v111, 0, v132
    v_fma_f32 v132, v112, 0, v132
    v_fma_f32 v132, v116, 0, v132
    v_fma_f32 v132, v117, 0, v132
    v_fma_f32 v132, v118, 0, v132
    v_fma_f32 v132, v119, 0, v132
    v_fma_f32 v132, v120, 0, v132
    v_fma_f32 v132, v121, 0, v132
    v_fma_f32 v132, v122, 0, v132
    v_fma_f32 v132, v123, 0, v132
    v_fma_f32 v132, v124, 0, v132
    v_fma_f32 v132, v125, 0, v132
    v_fma_f32 v132, v126, 0, v132
    v_fma_f32 v132, v127, 0, v132
    v_fma_f32 v132, v128, 0, v132
    v_cmp_u_f32 vcc, v132, v132
    v_mov_b32 v133, 71680
    v_mov_b32 v134, 1
    s_and_saveexec_b64 s[46:47], vcc
    s_cbranch_execz K2_NOFLAG
    ds_write_b32 v133, v134
K2_NOFLAG:
    s_mov_b64 exec, s[46:47]
    s_branch K2_EPI
K2_FALLBACK:
    s_nop 3
    s_mov_b32 s50, 1
    s_mov_b32 s44, 0
    v_mov_b32 v14, 0
    v_mov_b32 v15, 0
    v_mov_b32 v138, 0xff800000
    v_mov_b32 v26, 0
    v_mov_b32 v27, 0
    v_mov_b32 v139, 0xff800000
K2_MAXLOOP:
    s_barrier
    s_barrier
    s_mov_b32 s45, 0
    v_mov_b32 v145, v142
    v_mov_b32 v146, v143
K2_MAXT:
    ds_read_b128 v[28:31], v145 offset:0
    ds_read_b64 v[32:33], v146 offset:0
    v_add_u32 v145, 1024, v145
    v_add_u32 v146, 256, v146
    s_waitcnt lgkmcnt(0)
    v_mfma_f32_32x32x16_bf16 v[52:67], v[28:31], v[4:7], 0
    v_mfma_f32_32x32x16_bf16 v[52:67], v[32:35], v[12:15], v[52:67]
    v_mfma_f32_32x32x16_bf16 v[68:83], v[28:31], v[16:19], 0
    v_mfma_f32_32x32x16_bf16 v[68:83], v[32:35], v[24:27], v[68:83]
    s_nop 9
    v_max3_f32 v138, v138, v52, v53
    v_max3_f32 v138, v138, v54, v55
    v_max3_f32 v138, v138, v56, v57
    v_max3_f32 v138, v138, v58, v59
    v_max3_f32 v138, v138, v60, v61
    v_max3_f32 v138, v138, v62, v63
    v_max3_f32 v138, v138, v64, v65
    v_max3_f32 v138, v138, v66, v67
    v_max3_f32 v139, v139, v68, v69
    v_max3_f32 v139, v139, v70, v71
    v_max3_f32 v139, v139, v72, v73
    v_max3_f32 v139, v139, v74, v75
    v_max3_f32 v139, v139, v76, v77
    v_max3_f32 v139, v139, v78, v79
    v_max3_f32 v139, v139, v80, v81
    v_max3_f32 v139, v139, v82, v83
    s_add_u32 s45, s45, 1
    s_cmp_lt_u32 s45, 8
    s_cbranch_scc1 K2_MAXT
    s_add_u32 s44, s44, 1
    s_cmp_lt_u32 s44, 8
    s_cbranch_scc1 K2_MAXLOOP
    v_mov_b32 v133, v138
    s_nop 1
    v_permlane32_swap_b32 v138, v133
    v_max_f32 v138, v138, v133
    v_sub_f32 v140, 0xc2c80000, v138
    v_cvt_pk_bf16_f32 v134, 0, v140
    v_sub_f32 v135, v140, v134
    v_cvt_pk_bf16_f32 v136, 0, v135
    v_sub_f32 v135, v135, v136
    s_mov_b64 exec, 0xffffffff
    v_cvt_pk_bf16_f32 v14, v134, v136
    v_cvt_pk_bf16_f32 v15, v135, 0
    s_mov_b64 exec, -1
    v_mov_b32 v133, v139
    s_nop 1
    v_permlane32_swap_b32 v139, v133
    v_max_f32 v139, v139, v133
    v_sub_f32 v141, 0xc2c80000, v139
    v_cvt_pk_bf16_f32 v134, 0, v141
    v_sub_f32 v135, v141, v134
    v_cvt_pk_bf16_f32 v136, 0, v135
    v_sub_f32 v135, v135, v136
    s_mov_b64 exec, 0xffffffff
    v_cvt_pk_bf16_f32 v26, v134, v136
    v_cvt_pk_bf16_f32 v27, v135, 0
    s_mov_b64 exec, -1
    s_barrier
    s_branch K2_MAIN
K2_EPI:
    s_nop 15
    v_and_b32 v152, 31, v2
    v_add_u32 v152, s34, v152
    v_lshrrev_b32 v153, 4, v152
    v_mul_u32_u24 v153, 20480, v153
    v_and_b32 v152, 15, v152
    v_lshl_add_u32 v152, v152, 4, v153
    s_mov_b32 s36, 12058624
    s_mov_b32 s37, 12099584
    s_mul_i32 s35, s28, 5
    s_add_u32 s33, s35, 1
    s_lshr_b32 s33, s33, 1
    v_add_u32 v153, s33, v3
    v_lshl_add_u32 v156, v153, 8, v152
    s_and_b32 s38, s28, 1
    s_add_u32 s39, s33, 2
    s_lshl_b32 s39, s39, 8
    s_sub_u32 s33, s33, 1
    s_lshl_b32 s33, s33, 8
    s_add_u32 s33, s33, 8
    s_cmp_eq_u32 s38, 0
    s_cselect_b32 s33, s39, s33
    v_add_u32 v157, s33, v152
    v_rcp_f32 v132, v112
    s_nop 0
    v_mul_f32 v100, v100, v132
    v_mul_f32 v101, v101, v132
    v_mul_f32 v102, v102, v132
    v_mul_f32 v103, v103, v132
    v_mul_f32 v104, v104, v132
    v_mul_f32 v105, v105, v132
    v_mul_f32 v106, v106, v132
    v_mul_f32 v107, v107, v132
    v_mul_f32 v108, v108, v132
    v_mul_f32 v109, v109, v132
    v_mul_f32 v110, v110, v132
    v_mul_f32 v111, v111, v132
    v_cvt_pk_bf16_f32 v84, v100, v101
    v_cvt_pk_bf16_f32 v85, v102, v103
    v_cvt_pk_bf16_f32 v86, v104, v105
    v_cvt_pk_bf16_f32 v87, v106, v107
    v_cvt_pk_bf16_f32 v88, v108, v109
    v_cvt_pk_bf16_f32 v89, v110, v111
    v_rcp_f32 v132, v128
    s_nop 0
    v_mul_f32 v116, v116, v132
    v_mul_f32 v117, v117, v132
    v_mul_f32 v118, v118, v132
    v_mul_f32 v119, v119, v132
    v_mul_f32 v120, v120, v132
    v_mul_f32 v121, v121, v132
    v_mul_f32 v122, v122, v132
    v_mul_f32 v123, v123, v132
    v_mul_f32 v124, v124, v132
    v_mul_f32 v125, v125, v132
    v_mul_f32 v126, v126, v132
    v_mul_f32 v127, v127, v132
    v_cvt_pk_bf16_f32 v92, v116, v117
    v_cvt_pk_bf16_f32 v93, v118, v119
    v_cvt_pk_bf16_f32 v94, v120, v121
    v_cvt_pk_bf16_f32 v95, v122, v123
    v_cvt_pk_bf16_f32 v96, v124, v125
    v_cvt_pk_bf16_f32 v97, v126, v127
    s_cmp_lg_u32 s38, 0
    s_cbranch_scc1 K2_ODDH
    v_permlane32_swap_b32 v84, v86
    v_permlane32_swap_b32 v85, v87
    buffer_store_dwordx4 v[84:87], v156, s[24:27], s36 offen sc1
    v_permlane32_swap_b32 v92, v94
    v_permlane32_swap_b32 v93, v95
    buffer_store_dwordx4 v[92:95], v156, s[24:27], s37 offen sc1
    s_mov_b64 exec, 0xffffffff
    buffer_store_dwordx2 v[88:89], v157, s[24:27], s36 offen sc1
    buffer_store_dwordx2 v[96:97], v157, s[24:27], s37 offen sc1
    s_mov_b64 exec, -1
    s_branch K2_OST
K2_ODDH:
    s_nop 3
    s_mov_b64 exec, 0xffffffff
    buffer_store_dwordx2 v[84:85], v157, s[24:27], s36 offen sc1
    buffer_store_dwordx2 v[92:93], v157, s[24:27], s37 offen sc1
    s_mov_b64 exec, -1
    v_permlane32_swap_b32 v84, v88
    v_permlane32_swap_b32 v85, v89
    v_mov_b32 v100, v86
    v_mov_b32 v101, v87
    v_mov_b32 v102, v84
    v_mov_b32 v103, v85
    s_mov_b64 exec, 0xffffffff
    v_mov_b32 v100, v88
    v_mov_b32 v101, v89
    v_mov_b32 v102, v86
    v_mov_b32 v103, v87
    s_mov_b64 exec, -1
    buffer_store_dwordx4 v[100:103], v156, s[24:27], s36 offen sc1
    v_permlane32_swap_b32 v92, v96
    v_permlane32_swap_b32 v93, v97
    v_mov_b32 v116, v94
    v_mov_b32 v117, v95
    v_mov_b32 v118, v92
    v_mov_b32 v119, v93
    s_mov_b64 exec, 0xffffffff
    v_mov_b32 v116, v96
    v_mov_b32 v117, v97
    v_mov_b32 v118, v94
    v_mov_b32 v119, v95
    s_mov_b64 exec, -1
    buffer_store_dwordx4 v[116:119], v156, s[24:27], s37 offen sc1
K2_OST:
    s_nop 3
    s_waitcnt vmcnt(0) lgkmcnt(0)
    s_barrier
    s_cmp_lg_u32 s50, 0
    s_cbranch_scc1 K2_OK
    v_mov_b32 v133, 71680
    ds_read_b32 v134, v133
    s_waitcnt lgkmcnt(0)
    v_readfirstlane_b32 s46, v134
    s_nop 0
    s_cmp_lg_u32 s46, 0
    s_cbranch_scc1 K2_FALLBACK
K2_OK:
    s_cmp_lg_u32 s30, 0
    s_cbranch_scc1 K2_NOSIG
    v_mov_b32 v6, 1
    s_lshl_b32 s33, s29, 8
    s_add_u32 s33, s33, 14751744
    s_lshl_b32 s38, s28, 2
    v_mov_b32 v7, s38
    s_mov_b64 exec, 1
    buffer_store_dword v6, v7, s[24:27], s33 offen sc1
    s_mov_b64 exec, -1
K2_NOSIG:
    v_and_b32 v3, 15, v2
    v_lshrrev_b32 v4, 4, v2
    v_lshlrev_b32 v15, 4, v2
    v_mov_b32 v16, v214
    v_bfe_u32 v5, v2, 2, 2
    v_lshl_add_u32 v5, v4, 2, v5
    v_mul_u32_u24 v5, 160, v5
    v_and_b32 v6, 3, v2
    v_lshl_add_u32 v19, v6, 3, v5
    v_add_u32 v17, 71936, v19
    v_add_u32 v18, 112896, v19
    v_lshlrev_b32 v6, 16, v192
    v_and_b32 v7, 0xffff0000, v192
    v_sub_f32 v6, v6, v212
    v_sub_f32 v7, v7, v212
    v_cvt_pk_bf16_f32 v6, 0, v6
    v_cvt_pk_bf16_f32 v7, 0, v7
    v_mul_f32 v6, v6, v213
    v_mul_f32 v7, v7, v213
    v_cvt_pk_bf16_f32 v202, v6, v7
    v_lshlrev_b32 v6, 16, v193
    v_and_b32 v7, 0xffff0000, v193
    v_sub_f32 v6, v6, v212
    v_sub_f32 v7, v7, v212
    v_cvt_pk_bf16_f32 v6, 0, v6
    v_cvt_pk_bf16_f32 v7, 0, v7
    v_mul_f32 v6, v6, v213
    v_mul_f32 v7, v7, v213
    v_cvt_pk_bf16_f32 v203, v6, v7
    v_lshlrev_b32 v6, 16, v194
    v_and_b32 v7, 0xffff0000, v194
    v_sub_f32 v6, v6, v212
    v_sub_f32 v7, v7, v212
    v_cvt_pk_bf16_f32 v6, 0, v6
    v_cvt_pk_bf16_f32 v7, 0, v7
    v_mul_f32 v6, v6, v213
    v_mul_f32 v7, v7, v213
    v_cvt_pk_bf16_f32 v204, v6, v7
    v_lshlrev_b32 v6, 16, v195
    v_and_b32 v7, 0xffff0000, v195
    v_sub_f32 v6, v6, v212
    v_sub_f32 v7, v7, v212
    v_cvt_pk_bf16_f32 v6, 0, v6
    v_cvt_pk_bf16_f32 v7, 0, v7
    v_mul_f32 v6, v6, v213
    v_mul_f32 v7, v7, v213
    v_cvt_pk_bf16_f32 v205, v6, v7
    v_lshlrev_b32 v6, 16, v196
    v_and_b32 v7, 0xffff0000, v196
    v_sub_f32 v6, v6, v212
    v_sub_f32 v7, v7, v212
    v_cvt_pk_bf16_f32 v6, 0, v6
    v_cvt_pk_bf16_f32 v7, 0, v7
    v_mul_f32 v6, v6, v213
    v_mul_f32 v7, v7, v213
    v_cvt_pk_bf16_f32 v206, v6, v7
    v_lshlrev_b32 v6, 16, v197
    v_and_b32 v7, 0xffff0000, v197
    v_sub_f32 v6, v6, v212
    v_sub_f32 v7, v7, v212
    v_cvt_pk_bf16_f32 v6, 0, v6
    v_cvt_pk_bf16_f32 v7, 0, v7
    v_mul_f32 v6, v6, v213
    v_mul_f32 v7, v7, v213
    v_cvt_pk_bf16_f32 v207, v6, v7
    v_lshlrev_b32 v6, 16, v198
    v_and_b32 v7, 0xffff0000, v198
    v_sub_f32 v6, v6, v212
    v_sub_f32 v7, v7, v212
    v_cvt_pk_bf16_f32 v6, 0, v6
    v_cvt_pk_bf16_f32 v7, 0, v7
    v_mul_f32 v6, v6, v213
    v_mul_f32 v7, v7, v213
    v_cvt_pk_bf16_f32 v208, v6, v7
    v_lshlrev_b32 v6, 16, v199
    v_and_b32 v7, 0xffff0000, v199
    v_sub_f32 v6, v6, v212
    v_sub_f32 v7, v7, v212
    v_cvt_pk_bf16_f32 v6, 0, v6
    v_cvt_pk_bf16_f32 v7, 0, v7
    v_mul_f32 v6, v6, v213
    v_mul_f32 v7, v7, v213
    v_cvt_pk_bf16_f32 v209, v6, v7
    v_lshlrev_b32 v6, 16, v200
    v_and_b32 v7, 0xffff0000, v200
    v_sub_f32 v6, v6, v212
    v_sub_f32 v7, v7, v212
    v_cvt_pk_bf16_f32 v6, 0, v6
    v_cvt_pk_bf16_f32 v7, 0, v7
    v_mul_f32 v6, v6, v213
    v_mul_f32 v7, v7, v213
    v_cvt_pk_bf16_f32 v210, v6, v7
    v_lshlrev_b32 v6, 16, v201
    v_and_b32 v7, 0xffff0000, v201
    v_sub_f32 v6, v6, v212
    v_sub_f32 v7, v7, v212
    v_cvt_pk_bf16_f32 v6, 0, v6
    v_cvt_pk_bf16_f32 v7, 0, v7
    v_mul_f32 v6, v6, v213
    v_mul_f32 v7, v7, v213
    v_cvt_pk_bf16_f32 v211, v6, v7
    s_barrier
    s_lshr_b32 s36, s57, 4
    s_mul_i32 s36, s36, 20480
    s_add_u32 s36, s36, 12058624
    buffer_load_dwordx4 v[40:43], v15, s[24:27], s36 offen offset:0 sc1
    buffer_load_dwordx4 v[44:47], v15, s[24:27], s36 offen offset:1024 sc1
    buffer_load_dwordx4 v[48:51], v15, s[24:27], s36 offen offset:2048 sc1
    buffer_load_dwordx4 v[52:55], v15, s[24:27], s36 offen offset:3072 sc1
    s_add_u32 s36, s36, 4096
    buffer_load_dwordx4 v[56:59], v15, s[24:27], s36 offen offset:0 sc1
    buffer_load_dwordx4 v[60:63], v15, s[24:27], s36 offen offset:1024 sc1
    buffer_load_dwordx4 v[64:67], v15, s[24:27], s36 offen offset:2048 sc1
    buffer_load_dwordx4 v[68:71], v15, s[24:27], s36 offen offset:3072 sc1
    s_add_u32 s36, s36, 4096
    buffer_load_dwordx4 v[72:75], v15, s[24:27], s36 offen offset:0 sc1
    buffer_load_dwordx4 v[76:79], v15, s[24:27], s36 offen offset:1024 sc1
    buffer_load_dwordx4 v[80:83], v15, s[24:27], s36 offen offset:2048 sc1
    buffer_load_dwordx4 v[84:87], v15, s[24:27], s36 offen offset:3072 sc1
    s_add_u32 s36, s36, 4096
    buffer_load_dwordx4 v[88:91], v15, s[24:27], s36 offen offset:0 sc1
    buffer_load_dwordx4 v[92:95], v15, s[24:27], s36 offen offset:1024 sc1
    buffer_load_dwordx4 v[96:99], v15, s[24:27], s36 offen offset:2048 sc1
    buffer_load_dwordx4 v[100:103], v15, s[24:27], s36 offen offset:3072 sc1
    s_add_u32 s36, s36, 4096
    buffer_load_dwordx4 v[104:107], v15, s[24:27], s36 offen offset:0 sc1
    buffer_load_dwordx4 v[108:111], v15, s[24:27], s36 offen offset:1024 sc1
    buffer_load_dwordx4 v[112:115], v15, s[24:27], s36 offen offset:2048 sc1
    buffer_load_dwordx4 v[116:119], v15, s[24:27], s36 offen offset:3072 sc1
    v_mov_b32 v6, 0
    s_mov_b32 s38, 14688256
    buffer_load_dwordx4 v[8:11], v6, s[24:27], s38 offen sc1
    ds_read_b64_tr_b16 v[140:141], v17 offset:0
    ds_read_b64_tr_b16 v[142:143], v17 offset:2560
    ds_read_b64_tr_b16 v[144:145], v17 offset:32
    ds_read_b64_tr_b16 v[146:147], v17 offset:2592
    ds_read_b64_tr_b16 v[148:149], v17 offset:64
    ds_read_b64_tr_b16 v[150:151], v17 offset:2624
    ds_read_b64_tr_b16 v[152:153], v17 offset:96
    ds_read_b64_tr_b16 v[154:155], v17 offset:2656
    ds_read_b64_tr_b16 v[156:157], v17 offset:128
    ds_read_b64_tr_b16 v[158:159], v17 offset:2688
    ds_read_b64_tr_b16 v[160:161], v17 offset:5120
    ds_read_b64_tr_b16 v[162:163], v17 offset:7680
    ds_read_b64_tr_b16 v[164:165], v17 offset:5152
    ds_read_b64_tr_b16 v[166:167], v17 offset:7712
    ds_read_b64_tr_b16 v[168:169], v17 offset:5184
    ds_read_b64_tr_b16 v[170:171], v17 offset:7744
    ds_read_b64_tr_b16 v[172:173], v17 offset:5216
    ds_read_b64_tr_b16 v[174:175], v17 offset:7776
    ds_read_b64_tr_b16 v[176:177], v17 offset:5248
    ds_read_b64_tr_b16 v[178:179], v17 offset:7808
    s_waitcnt vmcnt(20) lgkmcnt(10)
    v_mfma_f32_16x16x32_bf16 v[20:23], v[140:143], v[40:43], 0
    v_mfma_f32_16x16x32_bf16 v[24:27], v[144:147], v[40:43], 0
    v_mfma_f32_16x16x32_bf16 v[28:31], v[148:151], v[40:43], 0
    v_mfma_f32_16x16x32_bf16 v[32:35], v[152:155], v[40:43], 0
    v_mfma_f32_16x16x32_bf16 v[36:39], v[156:159], v[40:43], 0
    ds_read_b64_tr_b16 v[140:141], v17 offset:10240
    ds_read_b64_tr_b16 v[142:143], v17 offset:12800
    ds_read_b64_tr_b16 v[144:145], v17 offset:10272
    ds_read_b64_tr_b16 v[146:147], v17 offset:12832
    ds_read_b64_tr_b16 v[148:149], v17 offset:10304
    ds_read_b64_tr_b16 v[150:151], v17 offset:12864
    ds_read_b64_tr_b16 v[152:153], v17 offset:10336
    ds_read_b64_tr_b16 v[154:155], v17 offset:12896
    ds_read_b64_tr_b16 v[156:157], v17 offset:10368
    ds_read_b64_tr_b16 v[158:159], v17 offset:12928
    s_waitcnt vmcnt(19) lgkmcnt(10)
    v_mfma_f32_16x16x32_bf16 v[20:23], v[160:163], v[44:47], v[20:23]
    v_mfma_f32_16x16x32_bf16 v[24:27], v[164:167], v[44:47], v[24:27]
    v_mfma_f32_16x16x32_bf16 v[28:31], v[168:171], v[44:47], v[28:31]
    v_mfma_f32_16x16x32_bf16 v[32:35], v[172:175], v[44:47], v[32:35]
    v_mfma_f32_16x16x32_bf16 v[36:39], v[176:179], v[44:47], v[36:39]
    ds_read_b64_tr_b16 v[160:161], v17 offset:15360
    ds_read_b64_tr_b16 v[162:163], v17 offset:17920
    ds_read_b64_tr_b16 v[164:165], v17 offset:15392
    ds_read_b64_tr_b16 v[166:167], v17 offset:17952
    ds_read_b64_tr_b16 v[168:169], v17 offset:15424
    ds_read_b64_tr_b16 v[170:171], v17 offset:17984
    ds_read_b64_tr_b16 v[172:173], v17 offset:15456
    ds_read_b64_tr_b16 v[174:175], v17 offset:18016
    ds_read_b64_tr_b16 v[176:177], v17 offset:15488
    ds_read_b64_tr_b16 v[178:179], v17 offset:18048
    s_waitcnt vmcnt(18) lgkmcnt(10)
    v_mfma_f32_16x16x32_bf16 v[20:23], v[140:143], v[48:51], v[20:23]
    v_mfma_f32_16x16x32_bf16 v[24:27], v[144:147], v[48:51], v[24:27]
    v_mfma_f32_16x16x32_bf16 v[28:31], v[148:151], v[48:51], v[28:31]
    v_mfma_f32_16x16x32_bf16 v[32:35], v[152:155], v[48:51], v[32:35]
    v_mfma_f32_16x16x32_bf16 v[36:39], v[156:159], v[48:51], v[36:39]
    ds_read_b64_tr_b16 v[140:141], v17 offset:20480
    ds_read_b64_tr_b16 v[142:143], v17 offset:23040
    ds_read_b64_tr_b16 v[144:145], v17 offset:20512
    ds_read_b64_tr_b16 v[146:147], v17 offset:23072
    ds_read_b64_tr_b16 v[148:149], v17 offset:20544
    ds_read_b64_tr_b16 v[150:151], v17 offset:23104
    ds_read_b64_tr_b16 v[152:153], v17 offset:20576
    ds_read_b64_tr_b16 v[154:155], v17 offset:23136
    ds_read_b64_tr_b16 v[156:157], v17 offset:20608
    ds_read_b64_tr_b16 v[158:159], v17 offset:23168
    s_waitcnt vmcnt(17) lgkmcnt(10)
    v_mfma_f32_16x16x32_bf16 v[20:23], v[160:163], v[52:55], v[20:23]
    v_mfma_f32_16x16x32_bf16 v[24:27], v[164:167], v[52:55], v[24:27]
    v_mfma_f32_16x16x32_bf16 v[28:31], v[168:171], v[52:55], v[28:31]
    v_mfma_f32_16x16x32_bf16 v[32:35], v[172:175], v[52:55], v[32:35]
    v_mfma_f32_16x16x32_bf16 v[36:39], v[176:179], v[52:55], v[36:39]
    ds_read_b64_tr_b16 v[160:161], v17 offset:25600
    ds_read_b64_tr_b16 v[162:163], v17 offset:28160
    ds_read_b64_tr_b16 v[164:165], v17 offset:25632
    ds_read_b64_tr_b16 v[166:167], v17 offset:28192
    ds_read_b64_tr_b16 v[168:169], v17 offset:25664
    ds_read_b64_tr_b16 v[170:171], v17 offset:28224
    ds_read_b64_tr_b16 v[172:173], v17 offset:25696
    ds_read_b64_tr_b16 v[174:175], v17 offset:28256
    ds_read_b64_tr_b16 v[176:177], v17 offset:25728
    ds_read_b64_tr_b16 v[178:179], v17 offset:28288
    s_waitcnt vmcnt(16) lgkmcnt(10)
    v_mfma_f32_16x16x32_bf16 v[20:23], v[140:143], v[56:59], v[20:23]
    v_mfma_f32_16x16x32_bf16 v[24:27], v[144:147], v[56:59], v[24:27]
    v_mfma_f32_16x16x32_bf16 v[28:31], v[148:151], v[56:59], v[28:31]
    v_mfma_f32_16x16x32_bf16 v[32:35], v[152:155], v[56:59], v[32:35]
    v_mfma_f32_16x16x32_bf16 v[36:39], v[156:159], v[56:59], v[36:39]
    ds_read_b64_tr_b16 v[140:141], v17 offset:30720
    ds_read_b64_tr_b16 v[142:143], v17 offset:33280
    ds_read_b64_tr_b16 v[144:145], v17 offset:30752
    ds_read_b64_tr_b16 v[146:147], v17 offset:33312
    ds_read_b64_tr_b16 v[148:149], v17 offset:30784
    ds_read_b64_tr_b16 v[150:151], v17 offset:33344
    ds_read_b64_tr_b16 v[152:153], v17 offset:30816
    ds_read_b64_tr_b16 v[154:155], v17 offset:33376
    ds_read_b64_tr_b16 v[156:157], v17 offset:30848
    ds_read_b64_tr_b16 v[158:159], v17 offset:33408
    s_waitcnt vmcnt(15) lgkmcnt(10)
    v_mfma_f32_16x16x32_bf16 v[20:23], v[160:163], v[60:63], v[20:23]
    v_mfma_f32_16x16x32_bf16 v[24:27], v[164:167], v[60:63], v[24:27]
    v_mfma_f32_16x16x32_bf16 v[28:31], v[168:171], v[60:63], v[28:31]
    v_mfma_f32_16x16x32_bf16 v[32:35], v[172:175], v[60:63], v[32:35]
    v_mfma_f32_16x16x32_bf16 v[36:39], v[176:179], v[60:63], v[36:39]
    ds_read_b64_tr_b16 v[160:161], v17 offset:35840
    ds_read_b64_tr_b16 v[162:163], v17 offset:38400
    ds_read_b64_tr_b16 v[164:165], v17 offset:35872
    ds_read_b64_tr_b16 v[166:167], v17 offset:38432
    ds_read_b64_tr_b16 v[168:169], v17 offset:35904
    ds_read_b64_tr_b16 v[170:171], v17 offset:38464
    ds_read_b64_tr_b16 v[172:173], v17 offset:35936
    ds_read_b64_tr_b16 v[174:175], v17 offset:38496
    ds_read_b64_tr_b16 v[176:177], v17 offset:35968
    ds_read_b64_tr_b16 v[178:179], v17 offset:38528
    s_waitcnt vmcnt(14) lgkmcnt(10)
    v_mfma_f32_16x16x32_bf16 v[20:23], v[140:143], v[64:67], v[20:23]
    v_mfma_f32_16x16x32_bf16 v[24:27], v[144:147], v[64:67], v[24:27]
    v_mfma_f32_16x16x32_bf16 v[28:31], v[148:151], v[64:67], v[28:31]
    v_mfma_f32_16x16x32_bf16 v[32:35], v[152:155], v[64:67], v[32:35]
    v_mfma_f32_16x16x32_bf16 v[36:39], v[156:159], v[64:67], v[36:39]
    ds_read_b64_tr_b16 v[140:141], v18 offset:0
    ds_read_b64_tr_b16 v[142:143], v18 offset:2560
    ds_read_b64_tr_b16 v[144:145], v18 offset:32
    ds_read_b64_tr_b16 v[146:147], v18 offset:2592
    ds_read_b64_tr_b16 v[148:149], v18 offset:64
    ds_read_b64_tr_b16 v[150:151], v18 offset:2624
    ds_read_b64_tr_b16 v[152:153], v18 offset:96
    ds_read_b64_tr_b16 v[154:155], v18 offset:2656
    ds_read_b64_tr_b16 v[156:157], v18 offset:128
    ds_read_b64_tr_b16 v[158:159], v18 offset:2688
    s_waitcnt vmcnt(13) lgkmcnt(10)
    v_mfma_f32_16x16x32_bf16 v[20:23], v[160:163], v[68:71], v[20:23]
    v_mfma_f32_16x16x32_bf16 v[24:27], v[164:167], v[68:71], v[24:27]
    v_mfma_f32_16x16x32_bf16 v[28:31], v[168:171], v[68:71], v[28:31]
    v_mfma_f32_16x16x32_bf16 v[32:35], v[172:175], v[68:71], v[32:35]
    v_mfma_f32_16x16x32_bf16 v[36:39], v[176:179], v[68:71], v[36:39]
    ds_read_b64_tr_b16 v[160:161], v18 offset:5120
    ds_read_b64_tr_b16 v[162:163], v18 offset:7680
    ds_read_b64_tr_b16 v[164:165], v18 offset:5152
    ds_read_b64_tr_b16 v[166:167], v18 offset:7712
    ds_read_b64_tr_b16 v[168:169], v18 offset:5184
    ds_read_b64_tr_b16 v[170:171], v18 offset:7744
    ds_read_b64_tr_b16 v[172:173], v18 offset:5216
    ds_read_b64_tr_b16 v[174:175], v18 offset:7776
    ds_read_b64_tr_b16 v[176:177], v18 offset:5248
    ds_read_b64_tr_b16 v[178:179], v18 offset:7808
    s_waitcnt vmcnt(12) lgkmcnt(10)
    v_mfma_f32_16x16x32_bf16 v[20:23], v[140:143], v[72:75], v[20:23]
    v_mfma_f32_16x16x32_bf16 v[24:27], v[144:147], v[72:75], v[24:27]
    v_mfma_f32_16x16x32_bf16 v[28:31], v[148:151], v[72:75], v[28:31]
    v_mfma_f32_16x16x32_bf16 v[32:35], v[152:155], v[72:75], v[32:35]
    v_mfma_f32_16x16x32_bf16 v[36:39], v[156:159], v[72:75], v[36:39]
    ds_read_b64_tr_b16 v[140:141], v18 offset:10240
    ds_read_b64_tr_b16 v[142:143], v18 offset:12800
    ds_read_b64_tr_b16 v[144:145], v18 offset:10272
    ds_read_b64_tr_b16 v[146:147], v18 offset:12832
    ds_read_b64_tr_b16 v[148:149], v18 offset:10304
    ds_read_b64_tr_b16 v[150:151], v18 offset:12864
    ds_read_b64_tr_b16 v[152:153], v18 offset:10336
    ds_read_b64_tr_b16 v[154:155], v18 offset:12896
    ds_read_b64_tr_b16 v[156:157], v18 offset:10368
    ds_read_b64_tr_b16 v[158:159], v18 offset:12928
    s_waitcnt vmcnt(11) lgkmcnt(10)
    v_mfma_f32_16x16x32_bf16 v[20:23], v[160:163], v[76:79], v[20:23]
    v_mfma_f32_16x16x32_bf16 v[24:27], v[164:167], v[76:79], v[24:27]
    v_mfma_f32_16x16x32_bf16 v[28:31], v[168:171], v[76:79], v[28:31]
    v_mfma_f32_16x16x32_bf16 v[32:35], v[172:175], v[76:79], v[32:35]
    v_mfma_f32_16x16x32_bf16 v[36:39], v[176:179], v[76:79], v[36:39]
    ds_read_b64_tr_b16 v[160:161], v18 offset:15360
    ds_read_b64_tr_b16 v[162:163], v18 offset:17920
    ds_read_b64_tr_b16 v[164:165], v18 offset:15392
    ds_read_b64_tr_b16 v[166:167], v18 offset:17952
    ds_read_b64_tr_b16 v[168:169], v18 offset:15424
    ds_read_b64_tr_b16 v[170:171], v18 offset:17984
    ds_read_b64_tr_b16 v[172:173], v18 offset:15456
    ds_read_b64_tr_b16 v[174:175], v18 offset:18016
    ds_read_b64_tr_b16 v[176:177], v18 offset:15488
    ds_read_b64_tr_b16 v[178:179], v18 offset:18048
    s_waitcnt vmcnt(10) lgkmcnt(10)
    v_mfma_f32_16x16x32_bf16 v[20:23], v[140:143], v[80:83], v[20:23]
    v_mfma_f32_16x16x32_bf16 v[24:27], v[144:147], v[80:83], v[24:27]
    v_mfma_f32_16x16x32_bf16 v[28:31], v[148:151], v[80:83], v[28:31]
    v_mfma_f32_16x16x32_bf16 v[32:35], v[152:155], v[80:83], v[32:35]
    v_mfma_f32_16x16x32_bf16 v[36:39], v[156:159], v[80:83], v[36:39]
    ds_read_b64_tr_b16 v[140:141], v18 offset:20480
    ds_read_b64_tr_b16 v[142:143], v18 offset:23040
    ds_read_b64_tr_b16 v[144:145], v18 offset:20512
    ds_read_b64_tr_b16 v[146:147], v18 offset:23072
    ds_read_b64_tr_b16 v[148:149], v18 offset:20544
    ds_read_b64_tr_b16 v[150:151], v18 offset:23104
    ds_read_b64_tr_b16 v[152:153], v18 offset:20576
    ds_read_b64_tr_b16 v[154:155], v18 offset:23136
    ds_read_b64_tr_b16 v[156:157], v18 offset:20608
    ds_read_b64_tr_b16 v[158:159], v18 offset:23168
    s_waitcnt vmcnt(9) lgkmcnt(10)
    v_mfma_f32_16x16x32_bf16 v[20:23], v[160:163], v[84:87], v[20:23]
    v_mfma_f32_16x16x32_bf16 v[24:27], v[164:167], v[84:87], v[24:27]
    v_mfma_f32_16x16x32_bf16 v[28:31], v[168:171], v[84:87], v[28:31]
    v_mfma_f32_16x16x32_bf16 v[32:35], v[172:175], v[84:87], v[32:35]
    v_mfma_f32_16x16x32_bf16 v[36:39], v[176:179], v[84:87], v[36:39]
    ds_read_b64_tr_b16 v[160:161], v18 offset:25600
    ds_read_b64_tr_b16 v[162:163], v18 offset:28160
    ds_read_b64_tr_b16 v[164:165], v18 offset:25632
    ds_read_b64_tr_b16 v[166:167], v18 offset:28192
    ds_read_b64_tr_b16 v[168:169], v18 offset:25664
    ds_read_b64_tr_b16 v[170:171], v18 offset:28224
    ds_read_b64_tr_b16 v[172:173], v18 offset:25696
    ds_read_b64_tr_b16 v[174:175], v18 offset:28256
    ds_read_b64_tr_b16 v[176:177], v18 offset:25728
    ds_read_b64_tr_b16 v[178:179], v18 offset:28288
    s_waitcnt vmcnt(8) lgkmcnt(10)
    v_mfma_f32_16x16x32_bf16 v[20:23], v[140:143], v[88:91], v[20:23]
    v_mfma_f32_16x16x32_bf16 v[24:27], v[144:147], v[88:91], v[24:27]
    v_mfma_f32_16x16x32_bf16 v[28:31], v[148:151], v[88:91], v[28:31]
    v_mfma_f32_16x16x32_bf16 v[32:35], v[152:155], v[88:91], v[32:35]
    v_mfma_f32_16x16x32_bf16 v[36:39], v[156:159], v[88:91], v[36:39]
    ds_read_b64_tr_b16 v[140:141], v18 offset:30720
    ds_read_b64_tr_b16 v[142:143], v18 offset:33280
    ds_read_b64_tr_b16 v[144:145], v18 offset:30752
    ds_read_b64_tr_b16 v[146:147], v18 offset:33312
    ds_read_b64_tr_b16 v[148:149], v18 offset:30784
    ds_read_b64_tr_b16 v[150:151], v18 offset:33344
    ds_read_b64_tr_b16 v[152:153], v18 offset:30816
    ds_read_b64_tr_b16 v[154:155], v18 offset:33376
    ds_read_b64_tr_b16 v[156:157], v18 offset:30848
    ds_read_b64_tr_b16 v[158:159], v18 offset:33408
    s_waitcnt vmcnt(7) lgkmcnt(10)
    v_mfma_f32_16x16x32_bf16 v[20:23], v[160:163], v[92:95], v[20:23]
    v_mfma_f32_16x16x32_bf16 v[24:27], v[164:167], v[92:95], v[24:27]
    v_mfma_f32_16x16x32_bf16 v[28:31], v[168:171], v[92:95], v[28:31]
    v_mfma_f32_16x16x32_bf16 v[32:35], v[172:175], v[92:95], v[32:35]
    v_mfma_f32_16x16x32_bf16 v[36:39], v[176:179], v[92:95], v[36:39]
    ds_read_b64_tr_b16 v[160:161], v18 offset:35840
    ds_read_b64_tr_b16 v[162:163], v18 offset:38400
    ds_read_b64_tr_b16 v[164:165], v18 offset:35872
    ds_read_b64_tr_b16 v[166:167], v18 offset:38432
    ds_read_b64_tr_b16 v[168:169], v18 offset:35904
    ds_read_b64_tr_b16 v[170:171], v18 offset:38464
    ds_read_b64_tr_b16 v[172:173], v18 offset:35936
    ds_read_b64_tr_b16 v[174:175], v18 offset:38496
    ds_read_b64_tr_b16 v[176:177], v18 offset:35968
    ds_read_b64_tr_b16 v[178:179], v18 offset:38528
    s_waitcnt vmcnt(6) lgkmcnt(10)
    v_mfma_f32_16x16x32_bf16 v[20:23], v[140:143], v[96:99], v[20:23]
    v_mfma_f32_16x16x32_bf16 v[24:27], v[144:147], v[96:99], v[24:27]
    v_mfma_f32_16x16x32_bf16 v[28:31], v[148:151], v[96:99], v[28:31]
    v_mfma_f32_16x16x32_bf16 v[32:35], v[152:155], v[96:99], v[32:35]
    v_mfma_f32_16x16x32_bf16 v[36:39], v[156:159], v[96:99], v[36:39]
    ds_read_b64_tr_b16 v[140:141], v19 offset:0
    ds_read_b64_tr_b16 v[142:143], v19 offset:2560
    ds_read_b64_tr_b16 v[144:145], v19 offset:32
    ds_read_b64_tr_b16 v[146:147], v19 offset:2592
    ds_read_b64_tr_b16 v[148:149], v19 offset:64
    ds_read_b64_tr_b16 v[150:151], v19 offset:2624
    ds_read_b64_tr_b16 v[152:153], v19 offset:96
    ds_read_b64_tr_b16 v[154:155], v19 offset:2656
    ds_read_b64_tr_b16 v[156:157], v19 offset:128
    ds_read_b64_tr_b16 v[158:159], v19 offset:2688
    s_waitcnt vmcnt(5) lgkmcnt(10)
    v_mfma_f32_16x16x32_bf16 v[20:23], v[160:163], v[100:103], v[20:23]
    v_mfma_f32_16x16x32_bf16 v[24:27], v[164:167], v[100:103], v[24:27]
    v_mfma_f32_16x16x32_bf16 v[28:31], v[168:171], v[100:103], v[28:31]
    v_mfma_f32_16x16x32_bf16 v[32:35], v[172:175], v[100:103], v[32:35]
    v_mfma_f32_16x16x32_bf16 v[36:39], v[176:179], v[100:103], v[36:39]
    ds_read_b64_tr_b16 v[160:161], v19 offset:5120
    ds_read_b64_tr_b16 v[162:163], v19 offset:7680
    ds_read_b64_tr_b16 v[164:165], v19 offset:5152
    ds_read_b64_tr_b16 v[166:167], v19 offset:7712
    ds_read_b64_tr_b16 v[168:169], v19 offset:5184
    ds_read_b64_tr_b16 v[170:171], v19 offset:7744
    ds_read_b64_tr_b16 v[172:173], v19 offset:5216
    ds_read_b64_tr_b16 v[174:175], v19 offset:7776
    ds_read_b64_tr_b16 v[176:177], v19 offset:5248
    ds_read_b64_tr_b16 v[178:179], v19 offset:7808
    s_waitcnt vmcnt(4) lgkmcnt(10)
    v_mfma_f32_16x16x32_bf16 v[20:23], v[140:143], v[104:107], v[20:23]
    v_mfma_f32_16x16x32_bf16 v[24:27], v[144:147], v[104:107], v[24:27]
    v_mfma_f32_16x16x32_bf16 v[28:31], v[148:151], v[104:107], v[28:31]
    v_mfma_f32_16x16x32_bf16 v[32:35], v[152:155], v[104:107], v[32:35]
    v_mfma_f32_16x16x32_bf16 v[36:39], v[156:159], v[104:107], v[36:39]
    ds_read_b64_tr_b16 v[140:141], v19 offset:10240
    ds_read_b64_tr_b16 v[142:143], v19 offset:12800
    ds_read_b64_tr_b16 v[144:145], v19 offset:10272
    ds_read_b64_tr_b16 v[146:147], v19 offset:12832
    ds_read_b64_tr_b16 v[148:149], v19 offset:10304
    ds_read_b64_tr_b16 v[150:151], v19 offset:12864
    ds_read_b64_tr_b16 v[152:153], v19 offset:10336
    ds_read_b64_tr_b16 v[154:155], v19 offset:12896
    ds_read_b64_tr_b16 v[156:157], v19 offset:10368
    ds_read_b64_tr_b16 v[158:159], v19 offset:12928
    s_waitcnt vmcnt(3) lgkmcnt(10)
    v_mfma_f32_16x16x32_bf16 v[20:23], v[160:163], v[108:111], v[20:23]
    v_mfma_f32_16x16x32_bf16 v[24:27], v[164:167], v[108:111], v[24:27]
    v_mfma_f32_16x16x32_bf16 v[28:31], v[168:171], v[108:111], v[28:31]
    v_mfma_f32_16x16x32_bf16 v[32:35], v[172:175], v[108:111], v[32:35]
    v_mfma_f32_16x16x32_bf16 v[36:39], v[176:179], v[108:111], v[36:39]
    ds_read_b64_tr_b16 v[160:161], v19 offset:15360
    ds_read_b64_tr_b16 v[162:163], v19 offset:17920
    ds_read_b64_tr_b16 v[164:165], v19 offset:15392
    ds_read_b64_tr_b16 v[166:167], v19 offset:17952
    ds_read_b64_tr_b16 v[168:169], v19 offset:15424
    ds_read_b64_tr_b16 v[170:171], v19 offset:17984
    ds_read_b64_tr_b16 v[172:173], v19 offset:15456
    ds_read_b64_tr_b16 v[174:175], v19 offset:18016
    ds_read_b64_tr_b16 v[176:177], v19 offset:15488
    ds_read_b64_tr_b16 v[178:179], v19 offset:18048
    s_waitcnt vmcnt(2) lgkmcnt(10)
    v_mfma_f32_16x16x32_bf16 v[20:23], v[140:143], v[112:115], v[20:23]
    v_mfma_f32_16x16x32_bf16 v[24:27], v[144:147], v[112:115], v[24:27]
    v_mfma_f32_16x16x32_bf16 v[28:31], v[148:151], v[112:115], v[28:31]
    v_mfma_f32_16x16x32_bf16 v[32:35], v[152:155], v[112:115], v[32:35]
    v_mfma_f32_16x16x32_bf16 v[36:39], v[156:159], v[112:115], v[36:39]
    s_waitcnt vmcnt(0) lgkmcnt(0)
    v_mfma_f32_16x16x32_bf16 v[20:23], v[160:163], v[116:119], v[20:23]
    v_mfma_f32_16x16x32_bf16 v[24:27], v[164:167], v[116:119], v[24:27]
    v_mfma_f32_16x16x32_bf16 v[28:31], v[168:171], v[116:119], v[28:31]
    v_mfma_f32_16x16x32_bf16 v[32:35], v[172:175], v[116:119], v[32:35]
    v_mfma_f32_16x16x32_bf16 v[36:39], v[176:179], v[116:119], v[36:39]
    v_readfirstlane_b32 s44, v8
    v_readfirstlane_b32 s45, v9
    v_readfirstlane_b32 s46, v10
    v_readfirstlane_b32 s47, v11
    s_lshr_b32 s33, s57, 4
    s_lshr_b32 s38, s44, 4
    s_cmp_lg_u32 s38, s33
    s_cbranch_scc1 K2_NOMOE0
    s_and_b32 s38, s44, 15
    v_cmp_eq_u32 vcc, s38, v3
    s_nop 0
    s_and_saveexec_b64 s[40:41], vcc
    v_lshlrev_b32 v5, 4, v4
    s_mul_i32 s39, s55, 320
    s_add_u32 s39, s39, 14745600
    buffer_load_dwordx4 v[140:143], v5, s[24:27], s39 offen offset:0 sc1
    buffer_load_dwordx4 v[144:147], v5, s[24:27], s39 offen offset:64 sc1
    buffer_load_dwordx4 v[148:151], v5, s[24:27], s39 offen offset:128 sc1
    buffer_load_dwordx4 v[152:155], v5, s[24:27], s39 offen offset:192 sc1
    buffer_load_dwordx4 v[156:159], v5, s[24:27], s39 offen offset:256 sc1
    s_waitcnt vmcnt(0)
    v_cvt_pk_bf16_f32 v140, 0, v140
    v_mul_f32 v140, s46, v140
    v_cvt_pk_bf16_f32 v140, 0, v140
    v_cvt_pk_bf16_f32 v141, 0, v141
    v_mul_f32 v141, s46, v141
    v_cvt_pk_bf16_f32 v141, 0, v141
    v_cvt_pk_bf16_f32 v142, 0, v142
    v_mul_f32 v142, s46, v142
    v_cvt_pk_bf16_f32 v142, 0, v142
    v_cvt_pk_bf16_f32 v143, 0, v143
    v_mul_f32 v143, s46, v143
    v_cvt_pk_bf16_f32 v143, 0, v143
    v_lshlrev_b32 v6, 16, v202
    v_and_b32 v7, 0xffff0000, v202
    v_add_f32 v6, v6, v140
    v_add_f32 v7, v7, v141
    v_cvt_pk_bf16_f32 v202, v6, v7
    v_lshlrev_b32 v6, 16, v203
    v_and_b32 v7, 0xffff0000, v203
    v_add_f32 v6, v6, v142
    v_add_f32 v7, v7, v143
    v_cvt_pk_bf16_f32 v203, v6, v7
    v_cvt_pk_bf16_f32 v144, 0, v144
    v_mul_f32 v144, s46, v144
    v_cvt_pk_bf16_f32 v144, 0, v144
    v_cvt_pk_bf16_f32 v145, 0, v145
    v_mul_f32 v145, s46, v145
    v_cvt_pk_bf16_f32 v145, 0, v145
    v_cvt_pk_bf16_f32 v146, 0, v146
    v_mul_f32 v146, s46, v146
    v_cvt_pk_bf16_f32 v146, 0, v146
    v_cvt_pk_bf16_f32 v147, 0, v147
    v_mul_f32 v147, s46, v147
    v_cvt_pk_bf16_f32 v147, 0, v147
    v_lshlrev_b32 v6, 16, v204
    v_and_b32 v7, 0xffff0000, v204
    v_add_f32 v6, v6, v144
    v_add_f32 v7, v7, v145
    v_cvt_pk_bf16_f32 v204, v6, v7
    v_lshlrev_b32 v6, 16, v205
    v_and_b32 v7, 0xffff0000, v205
    v_add_f32 v6, v6, v146
    v_add_f32 v7, v7, v147
    v_cvt_pk_bf16_f32 v205, v6, v7
    v_cvt_pk_bf16_f32 v148, 0, v148
    v_mul_f32 v148, s46, v148
    v_cvt_pk_bf16_f32 v148, 0, v148
    v_cvt_pk_bf16_f32 v149, 0, v149
    v_mul_f32 v149, s46, v149
    v_cvt_pk_bf16_f32 v149, 0, v149
    v_cvt_pk_bf16_f32 v150, 0, v150
    v_mul_f32 v150, s46, v150
    v_cvt_pk_bf16_f32 v150, 0, v150
    v_cvt_pk_bf16_f32 v151, 0, v151
    v_mul_f32 v151, s46, v151
    v_cvt_pk_bf16_f32 v151, 0, v151
    v_lshlrev_b32 v6, 16, v206
    v_and_b32 v7, 0xffff0000, v206
    v_add_f32 v6, v6, v148
    v_add_f32 v7, v7, v149
    v_cvt_pk_bf16_f32 v206, v6, v7
    v_lshlrev_b32 v6, 16, v207
    v_and_b32 v7, 0xffff0000, v207
    v_add_f32 v6, v6, v150
    v_add_f32 v7, v7, v151
    v_cvt_pk_bf16_f32 v207, v6, v7
    v_cvt_pk_bf16_f32 v152, 0, v152
    v_mul_f32 v152, s46, v152
    v_cvt_pk_bf16_f32 v152, 0, v152
    v_cvt_pk_bf16_f32 v153, 0, v153
    v_mul_f32 v153, s46, v153
    v_cvt_pk_bf16_f32 v153, 0, v153
    v_cvt_pk_bf16_f32 v154, 0, v154
    v_mul_f32 v154, s46, v154
    v_cvt_pk_bf16_f32 v154, 0, v154
    v_cvt_pk_bf16_f32 v155, 0, v155
    v_mul_f32 v155, s46, v155
    v_cvt_pk_bf16_f32 v155, 0, v155
    v_lshlrev_b32 v6, 16, v208
    v_and_b32 v7, 0xffff0000, v208
    v_add_f32 v6, v6, v152
    v_add_f32 v7, v7, v153
    v_cvt_pk_bf16_f32 v208, v6, v7
    v_lshlrev_b32 v6, 16, v209
    v_and_b32 v7, 0xffff0000, v209
    v_add_f32 v6, v6, v154
    v_add_f32 v7, v7, v155
    v_cvt_pk_bf16_f32 v209, v6, v7
    v_cvt_pk_bf16_f32 v156, 0, v156
    v_mul_f32 v156, s46, v156
    v_cvt_pk_bf16_f32 v156, 0, v156
    v_cvt_pk_bf16_f32 v157, 0, v157
    v_mul_f32 v157, s46, v157
    v_cvt_pk_bf16_f32 v157, 0, v157
    v_cvt_pk_bf16_f32 v158, 0, v158
    v_mul_f32 v158, s46, v158
    v_cvt_pk_bf16_f32 v158, 0, v158
    v_cvt_pk_bf16_f32 v159, 0, v159
    v_mul_f32 v159, s46, v159
    v_cvt_pk_bf16_f32 v159, 0, v159
    v_lshlrev_b32 v6, 16, v210
    v_and_b32 v7, 0xffff0000, v210
    v_add_f32 v6, v6, v156
    v_add_f32 v7, v7, v157
    v_cvt_pk_bf16_f32 v210, v6, v7
    v_lshlrev_b32 v6, 16, v211
    v_and_b32 v7, 0xffff0000, v211
    v_add_f32 v6, v6, v158
    v_add_f32 v7, v7, v159
    v_cvt_pk_bf16_f32 v211, v6, v7
    s_mov_b64 exec, s[40:41]
K2_NOMOE0:
    s_nop 3
    s_lshr_b32 s38, s45, 4
    s_cmp_lg_u32 s38, s33
    s_cbranch_scc1 K2_NOMOE1
    s_and_b32 s38, s45, 15
    v_cmp_eq_u32 vcc, s38, v3
    s_nop 0
    s_and_saveexec_b64 s[40:41], vcc
    v_lshlrev_b32 v5, 4, v4
    s_mul_i32 s39, s55, 320
    s_add_u32 s39, s39, 14748160
    buffer_load_dwordx4 v[140:143], v5, s[24:27], s39 offen offset:0 sc1
    buffer_load_dwordx4 v[144:147], v5, s[24:27], s39 offen offset:64 sc1
    buffer_load_dwordx4 v[148:151], v5, s[24:27], s39 offen offset:128 sc1
    buffer_load_dwordx4 v[152:155], v5, s[24:27], s39 offen offset:192 sc1
    buffer_load_dwordx4 v[156:159], v5, s[24:27], s39 offen offset:256 sc1
    s_waitcnt vmcnt(0)
    v_cvt_pk_bf16_f32 v140, 0, v140
    v_mul_f32 v140, s47, v140
    v_cvt_pk_bf16_f32 v140, 0, v140
    v_cvt_pk_bf16_f32 v141, 0, v141
    v_mul_f32 v141, s47, v141
    v_cvt_pk_bf16_f32 v141, 0, v141
    v_cvt_pk_bf16_f32 v142, 0, v142
    v_mul_f32 v142, s47, v142
    v_cvt_pk_bf16_f32 v142, 0, v142
    v_cvt_pk_bf16_f32 v143, 0, v143
    v_mul_f32 v143, s47, v143
    v_cvt_pk_bf16_f32 v143, 0, v143
    v_lshlrev_b32 v6, 16, v202
    v_and_b32 v7, 0xffff0000, v202
    v_add_f32 v6, v6, v140
    v_add_f32 v7, v7, v141
    v_cvt_pk_bf16_f32 v202, v6, v7
    v_lshlrev_b32 v6, 16, v203
    v_and_b32 v7, 0xffff0000, v203
    v_add_f32 v6, v6, v142
    v_add_f32 v7, v7, v143
    v_cvt_pk_bf16_f32 v203, v6, v7
    v_cvt_pk_bf16_f32 v144, 0, v144
    v_mul_f32 v144, s47, v144
    v_cvt_pk_bf16_f32 v144, 0, v144
    v_cvt_pk_bf16_f32 v145, 0, v145
    v_mul_f32 v145, s47, v145
    v_cvt_pk_bf16_f32 v145, 0, v145
    v_cvt_pk_bf16_f32 v146, 0, v146
    v_mul_f32 v146, s47, v146
    v_cvt_pk_bf16_f32 v146, 0, v146
    v_cvt_pk_bf16_f32 v147, 0, v147
    v_mul_f32 v147, s47, v147
    v_cvt_pk_bf16_f32 v147, 0, v147
    v_lshlrev_b32 v6, 16, v204
    v_and_b32 v7, 0xffff0000, v204
    v_add_f32 v6, v6, v144
    v_add_f32 v7, v7, v145
    v_cvt_pk_bf16_f32 v204, v6, v7
    v_lshlrev_b32 v6, 16, v205
    v_and_b32 v7, 0xffff0000, v205
    v_add_f32 v6, v6, v146
    v_add_f32 v7, v7, v147
    v_cvt_pk_bf16_f32 v205, v6, v7
    v_cvt_pk_bf16_f32 v148, 0, v148
    v_mul_f32 v148, s47, v148
    v_cvt_pk_bf16_f32 v148, 0, v148
    v_cvt_pk_bf16_f32 v149, 0, v149
    v_mul_f32 v149, s47, v149
    v_cvt_pk_bf16_f32 v149, 0, v149
    v_cvt_pk_bf16_f32 v150, 0, v150
    v_mul_f32 v150, s47, v150
    v_cvt_pk_bf16_f32 v150, 0, v150
    v_cvt_pk_bf16_f32 v151, 0, v151
    v_mul_f32 v151, s47, v151
    v_cvt_pk_bf16_f32 v151, 0, v151
    v_lshlrev_b32 v6, 16, v206
    v_and_b32 v7, 0xffff0000, v206
    v_add_f32 v6, v6, v148
    v_add_f32 v7, v7, v149
    v_cvt_pk_bf16_f32 v206, v6, v7
    v_lshlrev_b32 v6, 16, v207
    v_and_b32 v7, 0xffff0000, v207
    v_add_f32 v6, v6, v150
    v_add_f32 v7, v7, v151
    v_cvt_pk_bf16_f32 v207, v6, v7
    v_cvt_pk_bf16_f32 v152, 0, v152
    v_mul_f32 v152, s47, v152
    v_cvt_pk_bf16_f32 v152, 0, v152
    v_cvt_pk_bf16_f32 v153, 0, v153
    v_mul_f32 v153, s47, v153
    v_cvt_pk_bf16_f32 v153, 0, v153
    v_cvt_pk_bf16_f32 v154, 0, v154
    v_mul_f32 v154, s47, v154
    v_cvt_pk_bf16_f32 v154, 0, v154
    v_cvt_pk_bf16_f32 v155, 0, v155
    v_mul_f32 v155, s47, v155
    v_cvt_pk_bf16_f32 v155, 0, v155
    v_lshlrev_b32 v6, 16, v208
    v_and_b32 v7, 0xffff0000, v208
    v_add_f32 v6, v6, v152
    v_add_f32 v7, v7, v153
    v_cvt_pk_bf16_f32 v208, v6, v7
    v_lshlrev_b32 v6, 16, v209
    v_and_b32 v7, 0xffff0000, v209
    v_add_f32 v6, v6, v154
    v_add_f32 v7, v7, v155
    v_cvt_pk_bf16_f32 v209, v6, v7
    v_cvt_pk_bf16_f32 v156, 0, v156
    v_mul_f32 v156, s47, v156
    v_cvt_pk_bf16_f32 v156, 0, v156
    v_cvt_pk_bf16_f32 v157, 0, v157
    v_mul_f32 v157, s47, v157
    v_cvt_pk_bf16_f32 v157, 0, v157
    v_cvt_pk_bf16_f32 v158, 0, v158
    v_mul_f32 v158, s47, v158
    v_cvt_pk_bf16_f32 v158, 0, v158
    v_cvt_pk_bf16_f32 v159, 0, v159
    v_mul_f32 v159, s47, v159
    v_cvt_pk_bf16_f32 v159, 0, v159
    v_lshlrev_b32 v6, 16, v210
    v_and_b32 v7, 0xffff0000, v210
    v_add_f32 v6, v6, v156
    v_add_f32 v7, v7, v157
    v_cvt_pk_bf16_f32 v210, v6, v7
    v_lshlrev_b32 v6, 16, v211
    v_and_b32 v7, 0xffff0000, v211
    v_add_f32 v6, v6, v158
    v_add_f32 v7, v7, v159
    v_cvt_pk_bf16_f32 v211, v6, v7
    s_mov_b64 exec, s[40:41]
K2_NOMOE1:
    s_nop 3
    v_cvt_pk_bf16_f32 v20, 0, v20
    v_cvt_pk_bf16_f32 v21, 0, v21
    v_lshlrev_b32 v6, 16, v192
    v_and_b32 v7, 0xffff0000, v192
    v_add_f32 v20, v20, v6
    v_add_f32 v21, v21, v7
    v_cvt_pk_bf16_f32 v20, 0, v20
    v_cvt_pk_bf16_f32 v21, 0, v21
    v_lshlrev_b32 v6, 16, v202
    v_and_b32 v7, 0xffff0000, v202
    v_add_f32 v20, v20, v6
    v_add_f32 v21, v21, v7
    v_cvt_pk_bf16_f32 v192, v20, v21
    v_cvt_pk_bf16_f32 v22, 0, v22
    v_cvt_pk_bf16_f32 v23, 0, v23
    v_lshlrev_b32 v6, 16, v193
    v_and_b32 v7, 0xffff0000, v193
    v_add_f32 v22, v22, v6
    v_add_f32 v23, v23, v7
    v_cvt_pk_bf16_f32 v22, 0, v22
    v_cvt_pk_bf16_f32 v23, 0, v23
    v_lshlrev_b32 v6, 16, v203
    v_and_b32 v7, 0xffff0000, v203
    v_add_f32 v22, v22, v6
    v_add_f32 v23, v23, v7
    v_cvt_pk_bf16_f32 v193, v22, v23
    buffer_store_dwordx2 v[192:193], v16, s[20:23], 0 offen offset:0
    v_cvt_pk_bf16_f32 v24, 0, v24
    v_cvt_pk_bf16_f32 v25, 0, v25
    v_lshlrev_b32 v6, 16, v194
    v_and_b32 v7, 0xffff0000, v194
    v_add_f32 v24, v24, v6
    v_add_f32 v25, v25, v7
    v_cvt_pk_bf16_f32 v24, 0, v24
    v_cvt_pk_bf16_f32 v25, 0, v25
    v_lshlrev_b32 v6, 16, v204
    v_and_b32 v7, 0xffff0000, v204
    v_add_f32 v24, v24, v6
    v_add_f32 v25, v25, v7
    v_cvt_pk_bf16_f32 v194, v24, v25
    v_cvt_pk_bf16_f32 v26, 0, v26
    v_cvt_pk_bf16_f32 v27, 0, v27
    v_lshlrev_b32 v6, 16, v195
    v_and_b32 v7, 0xffff0000, v195
    v_add_f32 v26, v26, v6
    v_add_f32 v27, v27, v7
    v_cvt_pk_bf16_f32 v26, 0, v26
    v_cvt_pk_bf16_f32 v27, 0, v27
    v_lshlrev_b32 v6, 16, v205
    v_and_b32 v7, 0xffff0000, v205
    v_add_f32 v26, v26, v6
    v_add_f32 v27, v27, v7
    v_cvt_pk_bf16_f32 v195, v26, v27
    buffer_store_dwordx2 v[194:195], v16, s[20:23], 0 offen offset:32
    v_cvt_pk_bf16_f32 v28, 0, v28
    v_cvt_pk_bf16_f32 v29, 0, v29
    v_lshlrev_b32 v6, 16, v196
    v_and_b32 v7, 0xffff0000, v196
    v_add_f32 v28, v28, v6
    v_add_f32 v29, v29, v7
    v_cvt_pk_bf16_f32 v28, 0, v28
    v_cvt_pk_bf16_f32 v29, 0, v29
    v_lshlrev_b32 v6, 16, v206
    v_and_b32 v7, 0xffff0000, v206
    v_add_f32 v28, v28, v6
    v_add_f32 v29, v29, v7
    v_cvt_pk_bf16_f32 v196, v28, v29
    v_cvt_pk_bf16_f32 v30, 0, v30
    v_cvt_pk_bf16_f32 v31, 0, v31
    v_lshlrev_b32 v6, 16, v197
    v_and_b32 v7, 0xffff0000, v197
    v_add_f32 v30, v30, v6
    v_add_f32 v31, v31, v7
    v_cvt_pk_bf16_f32 v30, 0, v30
    v_cvt_pk_bf16_f32 v31, 0, v31
    v_lshlrev_b32 v6, 16, v207
    v_and_b32 v7, 0xffff0000, v207
    v_add_f32 v30, v30, v6
    v_add_f32 v31, v31, v7
    v_cvt_pk_bf16_f32 v197, v30, v31
    buffer_store_dwordx2 v[196:197], v16, s[20:23], 0 offen offset:64
    v_cvt_pk_bf16_f32 v32, 0, v32
    v_cvt_pk_bf16_f32 v33, 0, v33
    v_lshlrev_b32 v6, 16, v198
    v_and_b32 v7, 0xffff0000, v198
    v_add_f32 v32, v32, v6
    v_add_f32 v33, v33, v7
    v_cvt_pk_bf16_f32 v32, 0, v32
    v_cvt_pk_bf16_f32 v33, 0, v33
    v_lshlrev_b32 v6, 16, v208
    v_and_b32 v7, 0xffff0000, v208
    v_add_f32 v32, v32, v6
    v_add_f32 v33, v33, v7
    v_cvt_pk_bf16_f32 v198, v32, v33
    v_cvt_pk_bf16_f32 v34, 0, v34
    v_cvt_pk_bf16_f32 v35, 0, v35
    v_lshlrev_b32 v6, 16, v199
    v_and_b32 v7, 0xffff0000, v199
    v_add_f32 v34, v34, v6
    v_add_f32 v35, v35, v7
    v_cvt_pk_bf16_f32 v34, 0, v34
    v_cvt_pk_bf16_f32 v35, 0, v35
    v_lshlrev_b32 v6, 16, v209
    v_and_b32 v7, 0xffff0000, v209
    v_add_f32 v34, v34, v6
    v_add_f32 v35, v35, v7
    v_cvt_pk_bf16_f32 v199, v34, v35
    buffer_store_dwordx2 v[198:199], v16, s[20:23], 0 offen offset:96
    v_cvt_pk_bf16_f32 v36, 0, v36
    v_cvt_pk_bf16_f32 v37, 0, v37
    v_lshlrev_b32 v6, 16, v200
    v_and_b32 v7, 0xffff0000, v200
    v_add_f32 v36, v36, v6
    v_add_f32 v37, v37, v7
    v_cvt_pk_bf16_f32 v36, 0, v36
    v_cvt_pk_bf16_f32 v37, 0, v37
    v_lshlrev_b32 v6, 16, v210
    v_and_b32 v7, 0xffff0000, v210
    v_add_f32 v36, v36, v6
    v_add_f32 v37, v37, v7
    v_cvt_pk_bf16_f32 v200, v36, v37
    v_cvt_pk_bf16_f32 v38, 0, v38
    v_cvt_pk_bf16_f32 v39, 0, v39
    v_lshlrev_b32 v6, 16, v201
    v_and_b32 v7, 0xffff0000, v201
    v_add_f32 v38, v38, v6
    v_add_f32 v39, v39, v7
    v_cvt_pk_bf16_f32 v38, 0, v38
    v_cvt_pk_bf16_f32 v39, 0, v39
    v_lshlrev_b32 v6, 16, v211
    v_and_b32 v7, 0xffff0000, v211
    v_add_f32 v38, v38, v6
    v_add_f32 v39, v39, v7
    v_cvt_pk_bf16_f32 v201, v38, v39
    buffer_store_dwordx2 v[200:201], v16, s[20:23], 0 offen offset:128
    s_endpgm
K2_RC0:
    s_call_b64 s[60:61], K2_RECENTER
    s_branch K2_NR0
K2_RC4:
    s_call_b64 s[60:61], K2_RECENTER
    s_branch K2_NR4
K2_RECENTER:
    s_nop 15
    s_add_u32 s72, s72, 1
    v_mfma_f32_32x32x16_bf16 v[116:131], v[44:47], v[92:95], v[116:131]
    v_mfma_f32_32x32x16_bf16 v[116:131], v[48:51], v[96:99], v[116:131]
    v_mov_b32 v92, 0
    v_mov_b32 v93, 0
    v_mov_b32 v94, 0
    v_mov_b32 v95, 0
    v_mov_b32 v96, 0
    v_mov_b32 v97, 0
    v_mov_b32 v98, 0
    v_mov_b32 v99, 0
    v_frexp_exp_i32_f32 v132, v112
    v_sub_u32 v132, -99, v132
    v_ldexp_f32 v100, v100, v132
    v_ldexp_f32 v101, v101, v132
    v_ldexp_f32 v102, v102, v132
    v_ldexp_f32 v103, v103, v132
    v_ldexp_f32 v104, v104, v132
    v_ldexp_f32 v105, v105, v132
    v_ldexp_f32 v106, v106, v132
    v_ldexp_f32 v107, v107, v132
    v_ldexp_f32 v108, v108, v132
    v_ldexp_f32 v109, v109, v132
    v_ldexp_f32 v110, v110, v132
    v_ldexp_f32 v111, v111, v132
    v_ldexp_f32 v112, v112, v132
    v_cvt_f32_i32 v132, v132
    v_add_f32 v140, v140, v132
    v_add_f32 v52, v52, v132
    v_add_f32 v53, v53, v132
    v_add_f32 v54, v54, v132
    v_add_f32 v55, v55, v132
    v_add_f32 v56, v56, v132
    v_add_f32 v57, v57, v132
    v_add_f32 v58, v58, v132
    v_add_f32 v59, v59, v132
    v_add_f32 v60, v60, v132
    v_add_f32 v61, v61, v132
    v_add_f32 v62, v62, v132
    v_add_f32 v63, v63, v132
    v_add_f32 v64, v64, v132
    v_add_f32 v65, v65, v132
    v_add_f32 v66, v66, v132
    v_add_f32 v67, v67, v132
    v_cvt_pk_bf16_f32 v134, 0, v140
    v_sub_f32 v135, v140, v134
    v_cvt_pk_bf16_f32 v136, 0, v135
    v_sub_f32 v135, v135, v136
    s_mov_b64 exec, 0xffffffff
    v_cvt_pk_bf16_f32 v14, v134, v136
    v_cvt_pk_bf16_f32 v15, v135, 0
    s_mov_b64 exec, -1
    v_frexp_exp_i32_f32 v132, v128
    v_sub_u32 v132, -99, v132
    v_ldexp_f32 v116, v116, v132
    v_ldexp_f32 v117, v117, v132
    v_ldexp_f32 v118, v118, v132
    v_ldexp_f32 v119, v119, v132
    v_ldexp_f32 v120, v120, v132
    v_ldexp_f32 v121, v121, v132
    v_ldexp_f32 v122, v122, v132
    v_ldexp_f32 v123, v123, v132
    v_ldexp_f32 v124, v124, v132
    v_ldexp_f32 v125, v125, v132
    v_ldexp_f32 v126, v126, v132
    v_ldexp_f32 v127, v127, v132
    v_ldexp_f32 v128, v128, v132
    v_cvt_f32_i32 v132, v132
    v_add_f32 v141, v141, v132
    v_cvt_pk_bf16_f32 v134, 0, v141
    v_sub_f32 v135, v141, v134
    v_cvt_pk_bf16_f32 v136, 0, v135
    v_sub_f32 v135, v135, v136
    s_mov_b64 exec, 0xffffffff
    v_cvt_pk_bf16_f32 v26, v134, v136
    v_cvt_pk_bf16_f32 v27, v135, 0
    s_mov_b64 exec, -1
    s_nop 3
    s_setpc_b64 s[60:61]
K2_KVDMA:
    s_add_u32 m0, s42, 0
    s_add_u32 s48, s43, 0
    buffer_load_dwordx4 v150, s[24:27], s48 offen offset:0 lds
    buffer_load_dwordx4 v150, s[24:27], s48 offen offset:1024 lds
    buffer_load_dwordx4 v150, s[24:27], s48 offen offset:2048 lds
    buffer_load_dwordx4 v150, s[24:27], s48 offen offset:3072 lds
    s_add_u32 m0, s42, 4096
    s_add_u32 s48, s43, 4096
    buffer_load_dwordx4 v150, s[24:27], s48 offen offset:0 lds
    buffer_load_dwordx4 v150, s[24:27], s48 offen offset:1024 lds
    buffer_load_dwordx4 v150, s[24:27], s48 offen offset:2048 lds
    buffer_load_dwordx4 v150, s[24:27], s48 offen offset:3072 lds
    s_add_u32 m0, s42, 8192
    s_add_u32 s48, s43, 8192
    buffer_load_dwordx4 v150, s[24:27], s48 offen offset:0 lds
    buffer_load_dwordx4 v150, s[24:27], s48 offen offset:1024 lds
    s_add_u32 m0, s42, 10240
    s_add_u32 s48, s43, 2621440
    buffer_load_dwordx4 v150, s[24:27], s48 offen offset:0 lds
    buffer_load_dwordx4 v150, s[24:27], s48 offen offset:1024 lds
    buffer_load_dwordx4 v150, s[24:27], s48 offen offset:2048 lds
    buffer_load_dwordx4 v150, s[24:27], s48 offen offset:3072 lds
    s_add_u32 m0, s42, 14336
    s_add_u32 s48, s43, 2625536
    buffer_load_dwordx4 v150, s[24:27], s48 offen offset:0 lds
    buffer_load_dwordx4 v150, s[24:27], s48 offen offset:1024 lds
    buffer_load_dwordx4 v150, s[24:27], s48 offen offset:2048 lds
    buffer_load_dwordx4 v150, s[24:27], s48 offen offset:3072 lds
    s_add_u32 m0, s42, 18432
    s_add_u32 s48, s43, 2629632
    buffer_load_dwordx4 v150, s[24:27], s48 offen offset:0 lds
    buffer_load_dwordx4 v150, s[24:27], s48 offen offset:1024 lds
    s_add_u32 s43, s43, 10240
    s_mov_b32 s45, s40
    s_mov_b32 s40, s41
    s_mov_b32 s41, s42
    s_mov_b32 s42, s45
    s_setpc_b64 s[60:61]
K2_WODMA:
    s_add_u32 m0, s59, 0
    s_nop 0
    buffer_load_dwordx4 v10, s[16:19], s58 offen lds
    s_add_u32 m0, s59, 1024
    s_nop 0
    buffer_load_dwordx4 v11, s[16:19], s58 offen lds
    s_add_u32 m0, s59, 2048
    s_nop 0
    buffer_load_dwordx4 v12, s[16:19], s58 offen lds
    s_add_u32 m0, s59, 3072
    s_nop 0
    buffer_load_dwordx4 v13, s[16:19], s58 offen lds
    s_add_u32 m0, s59, 4096
    s_nop 0
    buffer_load_dwordx4 v14, s[16:19], s58 offen lds
    s_add_u32 s58, s58, 40960
    s_add_u32 s59, s59, 5120
    s_setpc_b64 s[62:63]
K2_PROD:
    s_nop 3
    s_load_dwordx4 s[64:67], s[0:1], 40
    s_load_dwordx2 s[68:69], s[0:1], 56
    s_mov_b32 s40, 40960
    s_mov_b32 s41, 0
    s_mov_b32 s42, 20480
    s_add_u32 s43, s32, 10240
    s_call_b64 s[60:61], K2_KVDMA
    s_mov_b32 s16, s6
    s_and_b32 s17, s7, 0xffff
    s_mov_b32 s18, 819200
    s_mov_b32 s19, 0x00020000
    v_add_u32 v5, 0, v2
    v_mul_u32_u24 v6, 52429, v5
    v_lshrrev_b32 v6, 19, v6
    v_mul_u32_u24 v7, 10, v6
    v_sub_u32 v7, v5, v7
    v_and_b32 v8, 3, v6
    v_bfe_u32 v9, v6, 2, 2
    v_lshl_add_u32 v8, v9, 3, v8
    v_lshrrev_b32 v9, 4, v6
    v_lshl_add_u32 v6, v9, 2, v8
    v_mul_u32_u24 v6, 1280, v6
    v_lshl_add_u32 v6, v7, 4, v6
    v_add_u32 v10, s56, v6
    v_add_u32 v5, 64, v2
    v_mul_u32_u24 v6, 52429, v5
    v_lshrrev_b32 v6, 19, v6
    v_mul_u32_u24 v7, 10, v6
    v_sub_u32 v7, v5, v7
    v_and_b32 v8, 3, v6
    v_bfe_u32 v9, v6, 2, 2
    v_lshl_add_u32 v8, v9, 3, v8
    v_lshrrev_b32 v9, 4, v6
    v_lshl_add_u32 v6, v9, 2, v8
    v_mul_u32_u24 v6, 1280, v6
    v_lshl_add_u32 v6, v7, 4, v6
    v_add_u32 v11, s56, v6
    v_add_u32 v5, 128, v2
    v_mul_u32_u24 v6, 52429, v5
    v_lshrrev_b32 v6, 19, v6
    v_mul_u32_u24 v7, 10, v6
    v_sub_u32 v7, v5, v7
    v_and_b32 v8, 3, v6
    v_bfe_u32 v9, v6, 2, 2
    v_lshl_add_u32 v8, v9, 3, v8
    v_lshrrev_b32 v9, 4, v6
    v_lshl_add_u32 v6, v9, 2, v8
    v_mul_u32_u24 v6, 1280, v6
    v_lshl_add_u32 v6, v7, 4, v6
    v_add_u32 v12, s56, v6
    v_add_u32 v5, 192, v2
    v_mul_u32_u24 v6, 52429, v5
    v_lshrrev_b32 v6, 19, v6
    v_mul_u32_u24 v7, 10, v6
    v_sub_u32 v7, v5, v7
    v_and_b32 v8, 3, v6
    v_bfe_u32 v9, v6, 2, 2
    v_lshl_add_u32 v8, v9, 3, v8
    v_lshrrev_b32 v9, 4, v6
    v_lshl_add_u32 v6, v9, 2, v8
    v_mul_u32_u24 v6, 1280, v6
    v_lshl_add_u32 v6, v7, 4, v6
    v_add_u32 v13, s56, v6
    v_add_u32 v5, 256, v2
    v_mul_u32_u24 v6, 52429, v5
    v_lshrrev_b32 v6, 19, v6
    v_mul_u32_u24 v7, 10, v6
    v_sub_u32 v7, v5, v7
    v_and_b32 v8, 3, v6
    v_bfe_u32 v9, v6, 2, 2
    v_lshl_add_u32 v8, v9, 3, v8
    v_lshrrev_b32 v9, 4, v6
    v_lshl_add_u32 v6, v9, 2, v8
    v_mul_u32_u24 v6, 1280, v6
    v_lshl_add_u32 v6, v7, 4, v6
    v_add_u32 v14, s56, v6
    s_mov_b32 s58, 0
    s_mov_b32 s59, 71936
    s_and_b32 s51, s2, 7
    s_mul_i32 s51, s51, 14
    s_lshr_b32 s45, s2, 3
    s_add_u32 s51, s51, s45
    s_cmp_ge_u32 s45, 14
    s_cbranch_scc1 K2_PPLAIN
    s_cmp_ge_u32 s51, 108
    s_cbranch_scc1 K2_PPLAIN
    s_mov_b32 s45, 14680064
    buffer_load_dwordx4 v[32:35], v150, s[24:27], s45 offen offset:0
    buffer_load_dwordx4 v[36:39], v150, s[24:27], s45 offen offset:1024
    buffer_load_dwordx4 v[40:43], v150, s[24:27], s45 offen offset:2048
    buffer_load_dwordx4 v[44:47], v150, s[24:27], s45 offen offset:3072
    s_mov_b32 s45, 14684160
    buffer_load_dwordx4 v[48:51], v150, s[24:27], s45 offen offset:0
    buffer_load_dwordx4 v[52:55], v150, s[24:27], s45 offen offset:1024
    buffer_load_dwordx4 v[56:59], v150, s[24:27], s45 offen offset:2048
    buffer_load_dwordx4 v[60:63], v150, s[24:27], s45 offen offset:3072
    s_waitcnt vmcnt(28) lgkmcnt(0)
    s_barrier
    s_mov_b32 s84, s64
    s_and_b32 s85, s65, 0xffff
    s_mov_b32 s86, 2211840
    s_mov_b32 s87, 0x00020000
    s_mov_b32 s88, s66
    s_and_b32 s89, s67, 0xffff
    s_mov_b32 s90, 2211840
    s_mov_b32 s91, 0x00020000
    s_mov_b32 s92, s68
    s_and_b32 s93, s69, 0xffff
    s_mov_b32 s94, 2211840
    s_mov_b32 s95, 0x00020000
    v_lshrrev_b32 v5, 1, v2
    v_mul_u32_u24 v16, 3456, v5
    v_and_b32 v5, 1, v2
    v_lshl_add_u32 v16, v5, 4, v16
    s_lshl_b32 s45, s51, 5
    v_add_u32 v16, s45, v16
    s_waitcnt vmcnt(0)
    v_max_u32 v18, v32, v33
    v_min_u32 v19, v32, v33
    v_max_u32 v21, v34, v35
    v_min_u32 v22, v34, v35
    v_min_u32 v20, v18, v21
    v_max_u32 v18, v18, v21
    v_max3_u32 v19, v20, v19, v22
    v_max_u32 v21, v36, v37
    v_min_u32 v22, v36, v37
    v_min_u32 v20, v18, v21
    v_max_u32 v18, v18, v21
    v_max3_u32 v19, v20, v19, v22
    v_max_u32 v21, v38, v39
    v_min_u32 v22, v38, v39
    v_min_u32 v20, v18, v21
    v_max_u32 v18, v18, v21
    v_max3_u32 v19, v20, v19, v22
    v_max_u32 v21, v40, v41
    v_min_u32 v22, v40, v41
    v_min_u32 v20, v18, v21
    v_max_u32 v18, v18, v21
    v_max3_u32 v19, v20, v19, v22
    v_max_u32 v21, v42, v43
    v_min_u32 v22, v42, v43
    v_min_u32 v20, v18, v21
    v_max_u32 v18, v18, v21
    v_max3_u32 v19, v20, v19, v22
    v_max_u32 v21, v44, v45
    v_min_u32 v22, v44, v45
    v_min_u32 v20, v18, v21
    v_max_u32 v18, v18, v21
    v_max3_u32 v19, v20, v19, v22
    v_max_u32 v21, v46, v47
    v_min_u32 v22, v46, v47
    v_min_u32 v20, v18, v21
    v_max_u32 v18, v18, v21
    v_max3_u32 v19, v20, v19, v22
    v_max_u32 v21, v48, v49
    v_min_u32 v22, v48, v49
    v_min_u32 v20, v18, v21
    v_max_u32 v18, v18, v21
    v_max3_u32 v19, v20, v19, v22
    v_max_u32 v21, v50, v51
    v_min_u32 v22, v50, v51
    v_min_u32 v20, v18, v21
    v_max_u32 v18, v18, v21
    v_max3_u32 v19, v20, v19, v22
    v_max_u32 v21, v52, v53
    v_min_u32 v22, v52, v53
    v_min_u32 v20, v18, v21
    v_max_u32 v18, v18, v21
    v_max3_u32 v19, v20, v19, v22
    v_max_u32 v21, v54, v55
    v_min_u32 v22, v54, v55
    v_min_u32 v20, v18, v21
    v_max_u32 v18, v18, v21
    v_max3_u32 v19, v20, v19, v22
    v_max_u32 v21, v56, v57
    v_min_u32 v22, v56, v57
    v_min_u32 v20, v18, v21
    v_max_u32 v18, v18, v21
    v_max3_u32 v19, v20, v19, v22
    v_max_u32 v21, v58, v59
    v_min_u32 v22, v58, v59
    v_min_u32 v20, v18, v21
    v_max_u32 v18, v18, v21
    v_max3_u32 v19, v20, v19, v22
    v_max_u32 v21, v60, v61
    v_min_u32 v22, v60, v61
    v_min_u32 v20, v18, v21
    v_max_u32 v18, v18, v21
    v_max3_u32 v19, v20, v19, v22
    v_max_u32 v21, v62, v63
    v_min_u32 v22, v62, v63
    v_min_u32 v20, v18, v21
    v_max_u32 v18, v18, v21
    v_max3_u32 v19, v20, v19, v22
    v_xor_b32 v23, 1, v2
    v_lshlrev_b32 v23, 2, v23
    ds_bpermute_b32 v21, v23, v18
    ds_bpermute_b32 v22, v23, v19
    s_waitcnt lgkmcnt(0)
    v_min_u32 v20, v18, v21
    v_max_u32 v18, v18, v21
    v_max3_u32 v19, v20, v19, v22
    v_xor_b32 v23, 2, v2
    v_lshlrev_b32 v23, 2, v23
    ds_bpermute_b32 v21, v23, v18
    ds_bpermute_b32 v22, v23, v19
    s_waitcnt lgkmcnt(0)
    v_min_u32 v20, v18, v21
    v_max_u32 v18, v18, v21
    v_max3_u32 v19, v20, v19, v22
    v_xor_b32 v23, 4, v2
    v_lshlrev_b32 v23, 2, v23
    ds_bpermute_b32 v21, v23, v18
    ds_bpermute_b32 v22, v23, v19
    s_waitcnt lgkmcnt(0)
    v_min_u32 v20, v18, v21
    v_max_u32 v18, v18, v21
    v_max3_u32 v19, v20, v19, v22
    v_xor_b32 v23, 8, v2
    v_lshlrev_b32 v23, 2, v23
    ds_bpermute_b32 v21, v23, v18
    ds_bpermute_b32 v22, v23, v19
    s_waitcnt lgkmcnt(0)
    v_min_u32 v20, v18, v21
    v_max_u32 v18, v18, v21
    v_max3_u32 v19, v20, v19, v22
    v_xor_b32 v23, 16, v2
    v_lshlrev_b32 v23, 2, v23
    ds_bpermute_b32 v21, v23, v18
    ds_bpermute_b32 v22, v23, v19
    s_waitcnt lgkmcnt(0)
    v_min_u32 v20, v18, v21
    v_max_u32 v18, v18, v21
    v_max3_u32 v19, v20, v19, v22
    v_xor_b32 v23, 32, v2
    v_lshlrev_b32 v23, 2, v23
    ds_bpermute_b32 v21, v23, v18
    ds_bpermute_b32 v22, v23, v19
    s_waitcnt lgkmcnt(0)
    v_min_u32 v20, v18, v21
    v_max_u32 v18, v18, v21
    v_max3_u32 v19, v20, v19, v22
    v_readfirstlane_b32 s70, v18
    v_readfirstlane_b32 s71, v19
    s_and_b32 s46, s70, 0xffff
    s_sub_u32 s46, 2047, s46
    s_and_b32 s47, s71, 0xffff
    s_sub_u32 s47, 2047, s47
    s_mov_b32 s96, s8
    s_and_b32 s97, s9, 0xffff
    s_mov_b32 s98, 2621440
    s_mov_b32 s99, 0x00020000
    v_mov_b32 v23, 0
    s_mul_i32 s45, s46, 1280
    s_mov_b32 m0, 133376
    s_nop 0
    buffer_load_dwordx4 v150, s[96:99], s45 offen lds
    s_mov_b64 exec, 0xffff
    buffer_load_dwordx4 v150, s[96:99], s45 offen offset:1024 lds
    s_mov_b64 exec, -1
    s_lshl_b32 s45, s46, 3
    s_add_u32 s45, s45, 9437184
    buffer_load_dwordx2 v[60:61], v23, s[24:27], s45 offen
    s_mul_i32 s45, s47, 1280
    s_mov_b32 m0, 134656
    s_nop 0
    buffer_load_dwordx4 v150, s[96:99], s45 offen lds
    s_mov_b64 exec, 0xffff
    buffer_load_dwordx4 v150, s[96:99], s45 offen offset:1024 lds
    s_mov_b64 exec, -1
    s_lshl_b32 s45, s47, 3
    s_add_u32 s45, s45, 9437184
    buffer_load_dwordx2 v[62:63], v23, s[24:27], s45 offen
    s_mov_b32 s45, 0
    s_mov_b32 m0, 71936
    s_nop 0
    buffer_load_dwordx4 v16, s[84:87], s45 offen lds
    s_mov_b32 m0, 92416
    s_nop 0
    buffer_load_dwordx4 v16, s[88:91], s45 offen lds
    s_mov_b32 s45, 110592
    s_mov_b32 m0, 72960
    s_nop 0
    buffer_load_dwordx4 v16, s[84:87], s45 offen lds
    s_mov_b32 m0, 93440
    s_nop 0
    buffer_load_dwordx4 v16, s[88:91], s45 offen lds
    s_mov_b32 s45, 221184
    s_mov_b32 m0, 73984
    s_nop 0
    buffer_load_dwordx4 v16, s[84:87], s45 offen lds
    s_mov_b32 m0, 94464
    s_nop 0
    buffer_load_dwordx4 v16, s[88:91], s45 offen lds
    s_mov_b32 s45, 331776
    s_mov_b32 m0, 75008
    s_nop 0
    buffer_load_dwordx4 v16, s[84:87], s45 offen lds
    s_mov_b32 m0, 95488
    s_nop 0
    buffer_load_dwordx4 v16, s[88:91], s45 offen lds
    s_mov_b32 s45, 442368
    s_mov_b32 m0, 76032
    s_nop 0
    buffer_load_dwordx4 v16, s[84:87], s45 offen lds
    s_mov_b32 m0, 96512
    s_nop 0
    buffer_load_dwordx4 v16, s[88:91], s45 offen lds
    s_mov_b32 s45, 552960
    s_mov_b32 m0, 77056
    s_nop 0
    buffer_load_dwordx4 v16, s[84:87], s45 offen lds
    s_mov_b32 m0, 97536
    s_nop 0
    buffer_load_dwordx4 v16, s[88:91], s45 offen lds
    s_mov_b32 s45, 663552
    s_mov_b32 m0, 78080
    s_nop 0
    buffer_load_dwordx4 v16, s[84:87], s45 offen lds
    s_mov_b32 m0, 98560
    s_nop 0
    buffer_load_dwordx4 v16, s[88:91], s45 offen lds
    s_mov_b32 s45, 774144
    s_mov_b32 m0, 79104
    s_nop 0
    buffer_load_dwordx4 v16, s[84:87], s45 offen lds
    s_mov_b32 m0, 99584
    s_nop 0
    buffer_load_dwordx4 v16, s[88:91], s45 offen lds
    s_barrier
    s_call_b64 s[60:61], K2_KVDMA
    s_mov_b32 s45, 884736
    s_mov_b32 m0, 80128
    s_nop 0
    buffer_load_dwordx4 v16, s[84:87], s45 offen lds
    s_mov_b32 m0, 100608
    s_nop 0
    buffer_load_dwordx4 v16, s[88:91], s45 offen lds
    s_mov_b32 s45, 995328
    s_mov_b32 m0, 81152
    s_nop 0
    buffer_load_dwordx4 v16, s[84:87], s45 offen lds
    s_mov_b32 m0, 101632
    s_nop 0
    buffer_load_dwordx4 v16, s[88:91], s45 offen lds
    s_mov_b32 s45, 1105920
    s_mov_b32 m0, 82176
    s_nop 0
    buffer_load_dwordx4 v16, s[84:87], s45 offen lds
    s_mov_b32 m0, 102656
    s_nop 0
    buffer_load_dwordx4 v16, s[88:91], s45 offen lds
    s_mov_b32 s45, 1216512
    s_mov_b32 m0, 83200
    s_nop 0
    buffer_load_dwordx4 v16, s[84:87], s45 offen lds
    s_mov_b32 m0, 103680
    s_nop 0
    buffer_load_dwordx4 v16, s[88:91], s45 offen lds
    s_mov_b32 s45, 1327104
    s_mov_b32 m0, 84224
    s_nop 0
    buffer_load_dwordx4 v16, s[84:87], s45 offen lds
    s_mov_b32 m0, 104704
    s_nop 0
    buffer_load_dwordx4 v16, s[88:91], s45 offen lds
    s_mov_b32 s45, 1437696
    s_mov_b32 m0, 85248
    s_nop 0
    buffer_load_dwordx4 v16, s[84:87], s45 offen lds
    s_mov_b32 m0, 105728
    s_nop 0
    buffer_load_dwordx4 v16, s[88:91], s45 offen lds
    s_mov_b32 s45, 1548288
    s_mov_b32 m0, 86272
    s_nop 0
    buffer_load_dwordx4 v16, s[84:87], s45 offen lds
    s_mov_b32 m0, 106752
    s_nop 0
    buffer_load_dwordx4 v16, s[88:91], s45 offen lds
    s_mov_b32 s45, 1658880
    s_mov_b32 m0, 87296
    s_nop 0
    buffer_load_dwordx4 v16, s[84:87], s45 offen lds
    s_mov_b32 m0, 107776
    s_nop 0
    buffer_load_dwordx4 v16, s[88:91], s45 offen lds
    s_mov_b32 s45, 1769472
    s_mov_b32 m0, 88320
    s_nop 0
    buffer_load_dwordx4 v16, s[84:87], s45 offen lds
    s_mov_b32 m0, 108800
    s_nop 0
    buffer_load_dwordx4 v16, s[88:91], s45 offen lds
    s_mov_b32 s45, 1880064
    s_mov_b32 m0, 89344
    s_nop 0
    buffer_load_dwordx4 v16, s[84:87], s45 offen lds
    s_mov_b32 m0, 109824
    s_nop 0
    buffer_load_dwordx4 v16, s[88:91], s45 offen lds
    s_mov_b32 s45, 1990656
    s_mov_b32 m0, 90368
    s_nop 0
    buffer_load_dwordx4 v16, s[84:87], s45 offen lds
    s_mov_b32 m0, 110848
    s_nop 0
    buffer_load_dwordx4 v16, s[88:91], s45 offen lds
    s_mov_b32 s45, 2101248
    s_mov_b32 m0, 91392
    s_nop 0
    buffer_load_dwordx4 v16, s[84:87], s45 offen lds
    s_mov_b32 m0, 111872
    s_nop 0
    buffer_load_dwordx4 v16, s[88:91], s45 offen lds
    s_waitcnt vmcnt(24)
    s_barrier
    s_call_b64 s[60:61], K2_KVDMA
    s_mul_i32 s45, s51, 20480
    s_mov_b32 m0, 112896
    s_nop 0
    buffer_load_dwordx4 v150, s[92:95], s45 offen offset:0 lds
    buffer_load_dwordx4 v150, s[92:95], s45 offen offset:1024 lds
    buffer_load_dwordx4 v150, s[92:95], s45 offen offset:2048 lds
    buffer_load_dwordx4 v150, s[92:95], s45 offen offset:3072 lds
    s_add_u32 s45, s45, 4096
    s_mov_b32 m0, 116992
    s_nop 0
    buffer_load_dwordx4 v150, s[92:95], s45 offen offset:0 lds
    buffer_load_dwordx4 v150, s[92:95], s45 offen offset:1024 lds
    buffer_load_dwordx4 v150, s[92:95], s45 offen offset:2048 lds
    buffer_load_dwordx4 v150, s[92:95], s45 offen offset:3072 lds
    s_add_u32 s45, s45, 4096
    s_mov_b32 m0, 121088
    s_nop 0
    buffer_load_dwordx4 v150, s[92:95], s45 offen offset:0 lds
    buffer_load_dwordx4 v150, s[92:95], s45 offen offset:1024 lds
    buffer_load_dwordx4 v150, s[92:95], s45 offen offset:2048 lds
    buffer_load_dwordx4 v150, s[92:95], s45 offen offset:3072 lds
    s_add_u32 s45, s45, 4096
    s_mov_b32 m0, 125184
    s_nop 0
    buffer_load_dwordx4 v150, s[92:95], s45 offen offset:0 lds
    buffer_load_dwordx4 v150, s[92:95], s45 offen offset:1024 lds
    buffer_load_dwordx4 v150, s[92:95], s45 offen offset:2048 lds
    buffer_load_dwordx4 v150, s[92:95], s45 offen offset:3072 lds
    s_add_u32 s45, s45, 4096
    s_mov_b32 m0, 129280
    s_nop 0
    buffer_load_dwordx4 v150, s[92:95], s45 offen offset:0 lds
    buffer_load_dwordx4 v150, s[92:95], s45 offen offset:1024 lds
    buffer_load_dwordx4 v150, s[92:95], s45 offen offset:2048 lds
    buffer_load_dwordx4 v150, s[92:95], s45 offen offset:3072 lds
    s_waitcnt vmcnt(20)
    s_barrier
    s_call_b64 s[60:61], K2_KVDMA
    v_lshrrev_b32 v4, 4, v2
    v_and_b32 v5, 1, v2
    v_mul_u32_u24 v20, 1280, v5
    v_add_u32 v20, 133376, v20
    v_mov_b32 v6, 61440
    v_and_b32 v7, 2, v2
    v_cmp_eq_u32 vcc, 0, v7
    s_nop 1
    v_cndmask_b32 v20, v6, v20, vcc
    v_lshl_add_u32 v20, v4, 3, v20
    v_bfe_u32 v6, v2, 2, 2
    v_lshl_add_u32 v6, v4, 2, v6
    v_and_b32 v7, 3, v2
    v_lshlrev_b32 v21, 5, v6
    v_lshl_add_u32 v21, v7, 3, v21
    v_add_u32 v21, 71936, v21
    v_mul_u32_u24 v22, 1280, v6
    v_lshl_add_u32 v22, v7, 3, v22
    v_add_u32 v22, 112896, v22
    v_mov_b32 v24, 0
    v_mov_b32 v25, 0
    v_mov_b32 v26, 0
    v_mov_b32 v27, 0
    v_mov_b32 v28, 0
    v_mov_b32 v29, 0
    v_mov_b32 v30, 0
    v_mov_b32 v31, 0
    s_mov_b32 s45, 0
K2_GU:
    ds_read_b64 v[32:33], v20 offset:0
    ds_read_b64 v[34:35], v20 offset:32
    ds_read_b64_tr_b16 v[36:37], v21 offset:0
    ds_read_b64_tr_b16 v[38:39], v21 offset:512
    ds_read_b64_tr_b16 v[40:41], v21 offset:20480
    ds_read_b64_tr_b16 v[42:43], v21 offset:20992
    ds_read_b64 v[44:45], v20 offset:64
    ds_read_b64 v[46:47], v20 offset:96
    ds_read_b64_tr_b16 v[48:49], v21 offset:1024
    ds_read_b64_tr_b16 v[50:51], v21 offset:1536
    ds_read_b64_tr_b16 v[52:53], v21 offset:21504
    ds_read_b64_tr_b16 v[54:55], v21 offset:22016
    v_add_u32 v20, 128, v20
    v_add_u32 v21, 2048, v21
    s_waitcnt lgkmcnt(0)
    v_mfma_f32_16x16x32_bf16 v[24:27], v[32:35], v[36:39], v[24:27]
    v_mfma_f32_16x16x32_bf16 v[28:31], v[32:35], v[40:43], v[28:31]
    v_mfma_f32_16x16x32_bf16 v[24:27], v[44:47], v[48:51], v[24:27]
    v_mfma_f32_16x16x32_bf16 v[28:31], v[44:47], v[52:55], v[28:31]
    s_add_u32 s45, s45, 1
    s_cmp_lt_u32 s45, 10
    s_cbranch_scc1 K2_GU
    s_waitcnt vmcnt(0)
    s_barrier
    s_call_b64 s[60:61], K2_KVDMA
    s_nop 0
    v_fma_f32 v24, -v60, v26, v24
    v_fma_f32 v28, -v60, v30, v28
    v_mul_f32 v24, v24, v61
    v_mul_f32 v28, v28, v61
    v_cvt_pk_bf16_f32 v24, 0, v24
    v_cvt_pk_bf16_f32 v28, 0, v28
    v_mul_f32 v32, 0xbfb8aa3b, v24
    v_exp_f32 v32, v32
    s_nop 0
    v_add_f32 v32, 1.0, v32
    v_rcp_f32 v32, v32
    s_nop 0
    v_mul_f32 v32, v24, v32
    v_cvt_pk_bf16_f32 v32, 0, v32
    v_mul_f32 v32, v32, v28
    v_cvt_pk_bf16_f32 v33, v32, 0
    v_fma_f32 v25, -v62, v26, v25
    v_fma_f32 v29, -v62, v30, v29
    v_mul_f32 v25, v25, v63
    v_mul_f32 v29, v29, v63
    v_cvt_pk_bf16_f32 v25, 0, v25
    v_cvt_pk_bf16_f32 v29, 0, v29
    v_mul_f32 v32, 0xbfb8aa3b, v25
    v_exp_f32 v32, v32
    s_nop 0
    v_add_f32 v32, 1.0, v32
    v_rcp_f32 v32, v32
    s_nop 0
    v_mul_f32 v32, v25, v32
    v_cvt_pk_bf16_f32 v32, 0, v32
    v_mul_f32 v32, v32, v29
    v_cvt_pk_bf16_f32 v34, v32, 0
    v_lshlrev_b32 v23, 1, v2
    v_add_u32 v23, 135936, v23
    s_mov_b64 exec, 0xffff
    ds_write_b16 v23, v33
    ds_write_b16 v23, v34 offset:32
    s_mov_b64 exec, -1
    v_lshlrev_b32 v23, 5, v5
    v_lshl_add_u32 v23, v4, 3, v23
    v_add_u32 v23, 135936, v23
    s_waitcnt lgkmcnt(0)
    ds_read_b64 v[24:25], v23
    v_mov_b32 v26, 0
    v_mov_b32 v27, 0
    v_mov_b32 v34, 0
    v_mov_b32 v35, 0
    v_mov_b32 v38, 0
    v_mov_b32 v39, 0
    v_mov_b32 v42, 0
    v_mov_b32 v43, 0
    v_mov_b32 v46, 0
    v_mov_b32 v47, 0
    v_lshlrev_b32 v23, 2, v2
    s_mov_b32 s46, 14745600
    s_mov_b32 s47, 0
K2_DN:
    ds_read_b64_tr_b16 v[32:33], v22 offset:0
    ds_read_b64_tr_b16 v[36:37], v22 offset:32
    ds_read_b64_tr_b16 v[40:41], v22 offset:64
    ds_read_b64_tr_b16 v[44:45], v22 offset:96
    v_add_u32 v22, 128, v22
    s_waitcnt lgkmcnt(0)
    v_mfma_f32_16x16x32_bf16 v[48:51], v[24:27], v[32:35], 0
    v_mfma_f32_16x16x32_bf16 v[52:55], v[24:27], v[36:39], 0
    v_mfma_f32_16x16x32_bf16 v[56:59], v[24:27], v[40:43], 0
    v_mfma_f32_16x16x32_bf16 v[60:63], v[24:27], v[44:47], 0
    s_mov_b64 exec, 0xffff
    s_nop 3
    buffer_atomic_add_f32 v48, v23, s[24:27], s46 offen offset:0
    buffer_atomic_add_f32 v49, v23, s[24:27], s46 offen offset:2560
    buffer_atomic_add_f32 v52, v23, s[24:27], s46 offen offset:64
    buffer_atomic_add_f32 v53, v23, s[24:27], s46 offen offset:2624
    buffer_atomic_add_f32 v56, v23, s[24:27], s46 offen offset:128
    buffer_atomic_add_f32 v57, v23, s[24:27], s46 offen offset:2688
    buffer_atomic_add_f32 v60, v23, s[24:27], s46 offen offset:192
    buffer_atomic_add_f32 v61, v23, s[24:27], s46 offen offset:2752
    s_mov_b64 exec, -1
    s_add_u32 s46, s46, 256
    s_add_u32 s47, s47, 1
    s_cmp_lg_u32 s47, 5
    s_cbranch_scc1 K2_DN1
    s_waitcnt vmcnt(40)
    s_barrier
    s_call_b64 s[60:61], K2_KVDMA
K2_DN1:
    s_cmp_lt_u32 s47, 10
    s_cbranch_scc1 K2_DN
    s_cmp_lg_u32 s51, 0
    s_cbranch_scc1 K2_NOIDX
    s_and_b32 s45, s70, 0xffff
    s_sub_u32 s45, 2047, s45
    v_mov_b32 v32, s45
    s_and_b32 s45, s70, 0xffff0000
    s_xor_b32 s46, s45, 0x80000000
    s_xor_b32 s47, s45, 0xffff0000
    s_bitcmp1_b32 s45, 31
    s_cselect_b32 s45, s46, s47
    v_mov_b32 v34, s45
    v_mul_f32 v34, 0xbfb8aa3b, v34
    v_exp_f32 v34, v34
    s_nop 0
    v_add_f32 v34, 1.0, v34
    v_rcp_f32 v34, v34
    s_nop 0
    v_cvt_pk_bf16_f32 v34, 0, v34
    s_and_b32 s45, s71, 0xffff
    s_sub_u32 s45, 2047, s45
    v_mov_b32 v33, s45
    s_and_b32 s45, s71, 0xffff0000
    s_xor_b32 s46, s45, 0x80000000
    s_xor_b32 s47, s45, 0xffff0000
    s_bitcmp1_b32 s45, 31
    s_cselect_b32 s45, s46, s47
    v_mov_b32 v35, s45
    v_mul_f32 v35, 0xbfb8aa3b, v35
    v_exp_f32 v35, v35
    s_nop 0
    v_add_f32 v35, 1.0, v35
    v_rcp_f32 v35, v35
    s_nop 0
    v_cvt_pk_bf16_f32 v35, 0, v35
    v_mov_b32 v23, 0
    s_mov_b32 s45, 14688256
    s_mov_b64 exec, 1
    buffer_store_dwordx4 v[32:35], v23, s[24:27], s45 offen sc1
    s_mov_b64 exec, -1
K2_NOIDX:
    s_nop 3
    s_waitcnt vmcnt(40)
    s_barrier
    s_call_b64 s[60:61], K2_KVDMA
    s_call_b64 s[62:63], K2_WODMA
    s_call_b64 s[62:63], K2_WODMA
    s_call_b64 s[62:63], K2_WODMA
    s_call_b64 s[62:63], K2_WODMA
    s_call_b64 s[62:63], K2_WODMA
    s_call_b64 s[62:63], K2_WODMA
    s_waitcnt vmcnt(30)
    s_barrier
    v_mov_b32 v23, 0
    v_mov_b32 v24, 1
    s_mov_b32 s45, 14753792
    s_mov_b64 exec, 1
    buffer_atomic_add v24, v23, s[24:27], s45 offen sc1
    s_mov_b64 exec, -1
    s_call_b64 s[62:63], K2_WODMA
    s_call_b64 s[62:63], K2_WODMA
    s_call_b64 s[62:63], K2_WODMA
    s_call_b64 s[62:63], K2_WODMA
    s_call_b64 s[62:63], K2_WODMA
    s_call_b64 s[62:63], K2_WODMA
    s_barrier
    s_branch K2_PTAIL
K2_PPLAIN:
    s_nop 3
    s_waitcnt vmcnt(20) lgkmcnt(0)
    s_barrier
    s_mov_b32 s44, 0
    s_waitcnt vmcnt(0)
K2_PLOOP:
    s_barrier
    s_cmp_ge_u32 s44, 6
    s_cbranch_scc1 K2_PNODMA
    s_call_b64 s[60:61], K2_KVDMA
K2_PNODMA:
    s_cmp_lg_u32 s50, 0
    s_cbranch_scc1 K2_PNOWO
    s_call_b64 s[62:63], K2_WODMA
    s_call_b64 s[62:63], K2_WODMA
    s_waitcnt vmcnt(10)
    s_branch K2_PNEXT
K2_PNOWO:
    s_waitcnt vmcnt(0)
K2_PNEXT:
    s_add_u32 s44, s44, 1
    s_cmp_lt_u32 s44, 8
    s_cbranch_scc1 K2_PLOOP
K2_PTAIL:
    s_nop 3
    v_mov_b32 v20, 0
    s_mov_b32 s44, 0
    s_mov_b32 s47, 14753792
    buffer_load_dword v26, v20, s[24:27], s47 offen sc1
K2_PGO:
    s_cmp_ge_u32 s58, 655360
    s_cbranch_scc1 K2_PGO2
    s_call_b64 s[62:63], K2_WODMA
    s_branch K2_PGO
K2_PGO2:
    s_mov_b32 s58, 655360
    s_mov_b32 s59, 0
    s_call_b64 s[62:63], K2_WODMA
    s_call_b64 s[62:63], K2_WODMA
    s_call_b64 s[62:63], K2_WODMA
    s_call_b64 s[62:63], K2_WODMA
    s_barrier
    s_cmp_lg_u32 s50, 0
    s_cbranch_scc1 K2_PPOLL
    v_mov_b32 v28, 71680
    ds_read_b32 v29, v28
    s_waitcnt lgkmcnt(0)
    v_readfirstlane_b32 s46, v29
    s_nop 0
    s_cmp_eq_u32 s46, 0
    s_cbranch_scc1 K2_PPOLL
    s_waitcnt vmcnt(0)
    s_mov_b32 s50, 1
    s_mov_b32 s43, s32
    s_mov_b32 s44, 0
K2_PMAX:
    s_barrier
    s_mov_b32 s42, 0
    s_call_b64 s[60:61], K2_KVDMA
    s_waitcnt vmcnt(0)
    s_barrier
    s_add_u32 s44, s44, 1
    s_cmp_lt_u32 s44, 8
    s_cbranch_scc1 K2_PMAX
    s_barrier
    s_mov_b32 s40, 20480
    s_mov_b32 s41, 40960
    s_mov_b32 s42, 0
    s_mov_b32 s43, s32
    s_call_b64 s[60:61], K2_KVDMA
    s_call_b64 s[60:61], K2_KVDMA
    s_branch K2_PPLAIN
K2_PPOLL:
    s_nop 3
    v_mov_b32 v20, 0
    s_mov_b64 exec, 1
    s_lshl_b32 s45, s29, 8
    s_add_u32 s45, s45, 14751744
    s_mov_b64 exec, 0xffffffff
    v_lshlrev_b32 v21, 2, v2
K2_POLL2:
    buffer_load_dword v22, v21, s[24:27], s45 offen sc1
    s_waitcnt vmcnt(0)
    v_cmp_ne_u32 vcc, 0, v22
    s_nop 0
    s_cmp_eq_u32 vcc_lo, -1
    s_cbranch_scc1 K2_PDONE
    s_sleep 4
    s_add_u32 s44, s44, 1
    s_cmp_lt_u32 s44, 1048576
    s_cbranch_scc1 K2_POLL2
K2_PDONE:
    s_mov_b32 s47, 14753792
K2_POLL1:
    v_readfirstlane_b32 s46, v26
    s_nop 0
    s_cmp_ge_u32 s46, 108
    s_cbranch_scc1 K2_POLL1_OK
    s_add_u32 s44, s44, 1
    s_cmp_ge_u32 s44, 1048576
    s_cbranch_scc1 K2_POLL1_OK
    s_sleep 4
    buffer_load_dword v26, v20, s[24:27], s47 offen sc1
    s_waitcnt vmcnt(0)
    s_branch K2_POLL1
K2_POLL1_OK:
    s_barrier
K2_END:
    s_endpgm
.section .rodata,"a"
.p2align 6
.amdhsa_kernel k1_kernel
  .amdhsa_next_free_vgpr 168
  .amdhsa_next_free_sgpr 102
  .amdhsa_accum_offset 168
  .amdhsa_group_segment_fixed_size 0
  .amdhsa_kernarg_size 88
  .amdhsa_user_sgpr_count 2
  .amdhsa_user_sgpr_kernarg_segment_ptr 1
  .amdhsa_system_sgpr_workgroup_id_x 1
  .amdhsa_float_denorm_mode_32 3
.end_amdhsa_kernel
.p2align 6
.amdhsa_kernel k2_kernel
  .amdhsa_next_free_vgpr 224
  .amdhsa_next_free_sgpr 102
  .amdhsa_accum_offset 224
  .amdhsa_group_segment_fixed_size 0
  .amdhsa_kernarg_size 88
  .amdhsa_user_sgpr_count 2
  .amdhsa_user_sgpr_kernarg_segment_ptr 1
  .amdhsa_system_sgpr_workgroup_id_x 1
  .amdhsa_float_denorm_mode_32 3
.end_amdhsa_kernel
```
